```python
import torch

def _softmax(x, axis=-1):
    return torch.softmax(x, dim=axis)
def _gelu(x):
    return torch.nn.functional.gelu(x, approximate="tanh")
def _silu(x):
    return torch.nn.functional.silu(x)
def _sigmoid(x):
    return torch.sigmoid(x)
def _layernorm(x, axis=-1, eps=1e-5):
    m = x.mean(dim=axis, keepdim=True)
    v = x.var(dim=axis, keepdim=True, unbiased=False)
    return (x - m) / torch.sqrt(v + eps)
def _scatter_add(tgt, idx, src, axis=0):
    return tgt.clone().index_add_(axis, idx, src)
def _segment_sum(src, seg, n):
    out = torch.zeros((n,) + src.shape[1:], dtype=src.dtype)
    return out.index_add_(0, seg, src)
def _pad(x, pw):
    flat = tuple(v for pair in reversed(pw) for v in pair)
    return torch.nn.functional.pad(x, flat)

kernel_name = 'standalone__winograd__vision'

def setup_inputs():

    _w = (lambda a: (lambda t: t.to(torch.bfloat16) if t.is_floating_point() else t)(torch.as_tensor(a)))
    H = W = 384 // 2 * 2
    C = 96
    return {
        "x": _w((lambda *s: torch.randn(*s, dtype=torch.bfloat16) * 0.05)(1, H, W, C)),
        "w": _w((lambda *s: torch.randn(*s, dtype=torch.bfloat16) * 0.05)(3, 3, C, C)),
    }

def reference(x, w):
    N, H, W, C = x.shape
    K = w.shape[-1]
    G  = torch.as_tensor([[1.0,0.0,0.0],[0.5,0.5,0.5],[0.5,-0.5,0.5],[0.0,0.0,1.0]], dtype=x.dtype)
    Bt = torch.as_tensor([[1.0,0.0,-1.0,0.0],[0.0,1.0,1.0,0.0],[0.0,-1.0,1.0,0.0],[0.0,1.0,0.0,-1.0]], dtype=x.dtype)
    At = torch.as_tensor([[1.0,1.0,1.0,0.0],[0.0,1.0,-1.0,-1.0]], dtype=x.dtype)
    U = torch.einsum("ar,rsck,bs->abck", G, w, G)
    xp = _pad(x, ((0,0),(1,1),(1,1),(0,0)))
    nH, nW = H // 2, W // 2
    patches = []
    for i in range(4):
        for j in range(4):
            patches.append(xp[:, i:i + 2 * nH:2, j:j + 2 * nW:2, :])
    d = torch.stack(patches).reshape(4, 4, N * nH * nW, C)
    V = torch.einsum("ai,ijpc,bj->abpc", Bt, d, Bt)
    M = torch.einsum("abck,abpc->abpk", U, V)
    Y = torch.einsum("ma,abpk,nb->pmnk", At, M, At)
    Y = Y.reshape(N, nH, nW, 2, 2, K)
    Y = (lambda x, *d: x.permute(*d))(Y, 0, 1, 3, 2, 4, 5).reshape(N, H, W, K)
    return Y
```

```asm
; @launch grid=(256,1,1) block=(256,1,1) lds=163840
.amdgcn_target "amdgcn-amd-amdhsa--gfx950"
.text
.globl standalone__winograd__vision_kernel
.p2align 8
.type standalone__winograd__vision_kernel,@function
standalone__winograd__vision_kernel:
s_cmp_ge_u32 s2, 256
s_cbranch_scc1 Lend
s_load_dwordx4 s[4:7], s[0:1], 0
s_load_dwordx2 s[8:9], s[0:1], 16
s_getpc_b64 s[84:85]
Lpc:
v_lshrrev_b32 v1, 6, v0
v_and_b32 v0, 63, v0
v_readfirstlane_b32 s28, v1
s_lshr_b32 s33, s2, 3
s_and_b32 s32, s2, 7
s_mov_b32 s86, Lend-Lpc
s_mov_b32 s87, 0x20000
v_lshlrev_b32 v1, 7, v0
s_lshl_b32 s3, s33, 2
s_add_u32 s3, s3, s28
s_lshl_b32 s30, s3, 8
s_mov_b64 exec, 3
buffer_load_dword a254, v1, s[84:87], s30 offen
s_mul_i32 s3, s3, 1408
s_lshl_b32 s32, s32, 5
s_add_u32 s32, s32, s33
s_mul_i32 s30, s32, 18
s_lshr_b32 s29, s28, 1
s_mov_b64 exec, -1
s_mul_i32 s35, s30, 683
s_lshr_b32 s35, s35, 18
s_mul_i32 s32, s35, 384
s_sub_u32 s34, s30, s32
s_sub_u32 s31, 384, s34
s_mul_i32 s32, s29, 192
s_add_u32 s32, s32, 12
s_movk_i32 s33, 2731
v_add_u32 v5, s32, v0
v_mul_u32_u24 v13, s33, v5
v_lshrrev_b32 v13, 16, v13
v_and_b32 v13, 6, v13
v_xor_b32 v5, v13, v5
v_lshlrev_b32 v5, 4, v5
v_add_u32 v6, s32, v0
v_add_u32 v6, 64, v6
v_mul_u32_u24 v13, s33, v6
v_lshrrev_b32 v13, 16, v13
v_and_b32 v13, 6, v13
v_xor_b32 v6, v13, v6
v_lshlrev_b32 v6, 4, v6
v_subrev_u32 v6, 1024, v6
v_add_u32 v7, s32, v0
v_add_u32 v7, 128, v7
v_mul_u32_u24 v13, s33, v7
v_lshrrev_b32 v13, 16, v13
v_and_b32 v13, 6, v13
v_xor_b32 v7, v13, v7
v_lshlrev_b32 v7, 4, v7
v_subrev_u32 v7, 2048, v7
s_mul_i32 s33, s29, 1568
v_add_u32 v8, s33, v0
v_lshlrev_b32 v8, 2, v8
s_lshl_b32 s33, s29, 4
v_subrev_u32 v13, s33, v0
v_min_u32 v13, 48, v13
v_subrev_u32 v13, 48, v13
v_ashrrev_i32 v12, 31, v13
s_lshl_b32 s40, s32, 4
s_add_u32 s47, s40, 130560
s_mul_i32 s41, s29, 3200
s_sub_u32 s41, s41, 192
s_mul_i32 s42, s29, 11
s_cmp_eq_u32 s31, 18
s_cselect_b32 s43, 19, 20
s_cmp_eq_u32 s34, 0
s_cselect_b32 s11, 0, -1
s_cselect_b32 s37, 384, s34
s_subb_u32 s38, s35, 0
s_sub_u32 s37, s37, 1
s_mul_i32 s36, s37, 73728
s_mul_i32 s33, s38, 6144
s_add_u32 s36, s36, s33
s_mov_b32 s39, 0
s_mov_b32 s48, 73728
s_mov_b32 s14, 28311744
s_mov_b32 s15, 0x20000
s_bitcmp1_b32 s2, 3
s_cselect_b32 s10, 2, 0
v_mov_b32 v10, 0
v_accvgpr_write_b32 a244, 0
v_accvgpr_write_b32 a245, 0
v_accvgpr_write_b32 a246, 0
v_accvgpr_write_b32 a247, 0
s_mul_i32 s50, s29, 21504
s_mul_i32 s51, s29, 33792
s_mul_i32 s55, s29, 9216
v_lshlrev_b32 v11, 4, v0
s_movk_i32 s33, 1366
v_add_u32 v13, 0, v0
v_mul_u32_u24 v13, s33, v13
v_lshrrev_b32 v13, 15, v13
v_and_b32 v13, 2, v13
v_xor_b32 v13, v13, v0
v_lshlrev_b32 v16, 4, v13
v_add_u32 v13, 64, v0
v_mul_u32_u24 v13, s33, v13
v_lshrrev_b32 v13, 15, v13
v_and_b32 v13, 2, v13
v_xor_b32 v13, v13, v0
v_lshlrev_b32 v17, 4, v13
v_add_u32 v13, 128, v0
v_mul_u32_u24 v13, s33, v13
v_lshrrev_b32 v13, 15, v13
v_and_b32 v13, 2, v13
v_xor_b32 v13, v13, v0
v_lshlrev_b32 v18, 4, v13
s_mov_b32 s18, 165888
s_mov_b32 s19, 0x20000
s_mov_b64 exec, 2047
s_waitcnt lgkmcnt(0)
s_mov_b32 s16, s6
s_mov_b32 s17, s7
s_sub_u32 s12, s4, 192
s_subb_u32 s13, s5, 0
buffer_load_dword a255, v1, s[16:19], s3 offen
s_mov_b64 exec, -1
s_add_u32 s3, s28, 1
s_bitcmp1_b32 s3, 1
s_cbranch_scc1 Lprod
s_cmp_eq_u32 s10, 0
s_cbranch_scc1 Lnoearly
s_cmp_eq_u32 s39, s11
s_cselect_b32 s44, 2.0, s36
s_mov_b32 m0, s40
s_cmp_eq_u32 s38, s42
s_cselect_b32 s45, 2.0, 0
buffer_load_dwordx4 v5, s[12:15], s44 offen offset:0 nt lds
buffer_load_dwordx4 v6, s[12:15], s44 offen offset:1024 nt lds
buffer_load_dwordx4 v7, s[12:15], s44 offen offset:2048 nt lds
s_add_u32 m0, s40, s41
s_add_u32 s37, s37, 1
s_add_u32 s39, s39, 1
v_and_or_b32 v13, v12, s45, v8
buffer_load_dword v13, s[12:15], s44 offen nt lds
s_cmp_eq_u32 s37, 384
s_cselect_b32 s37, 0, s37
s_addc_u32 s38, s38, 0
s_cmp_eq_u32 s37, 0
s_cselect_b32 s49, -28231680, s48
s_add_u32 s36, s36, s49
s_add_u32 s40, s40, 6528
s_min_u32 s40, s40, s47
s_cmp_ge_u32 s39, s43
s_cselect_b32 s44, 2.0, s36
s_mov_b32 m0, s40
s_cmp_eq_u32 s38, s42
s_cselect_b32 s45, 2.0, 0
buffer_load_dwordx4 v5, s[12:15], s44 offen offset:0 nt lds
buffer_load_dwordx4 v6, s[12:15], s44 offen offset:1024 nt lds
buffer_load_dwordx4 v7, s[12:15], s44 offen offset:2048 nt lds
s_add_u32 m0, s40, s41
s_add_u32 s37, s37, 1
s_add_u32 s39, s39, 1
v_and_or_b32 v13, v12, s45, v8
buffer_load_dword v13, s[12:15], s44 offen nt lds
s_cmp_eq_u32 s37, 384
s_cselect_b32 s37, 0, s37
s_addc_u32 s38, s38, 0
s_cmp_eq_u32 s37, 0
s_cselect_b32 s49, -28231680, s48
s_add_u32 s36, s36, s49
s_add_u32 s40, s40, 6528
s_min_u32 s40, s40, s47
Lnoearly:
s_add_u32 m0, s55, 108544
s_add_u32 s99, s50, 0
buffer_load_dwordx4 v16, s[16:19], s99 offen offset:0 lds
buffer_load_dwordx4 v17, s[16:19], s99 offen offset:1024 lds
buffer_load_dwordx4 v18, s[16:19], s99 offen offset:2048 lds
s_add_u32 m0, s55, 111616
s_add_u32 s99, s51, 3072
buffer_load_dwordx4 v16, s[16:19], s99 offen offset:0 lds
buffer_load_dwordx4 v17, s[16:19], s99 offen offset:1024 lds
buffer_load_dwordx4 v18, s[16:19], s99 offen offset:2048 lds
s_add_u32 m0, s55, 114688
s_add_u32 s99, s50, 18432
buffer_load_dwordx4 v16, s[16:19], s99 offen offset:0 lds
buffer_load_dwordx4 v17, s[16:19], s99 offen offset:1024 lds
buffer_load_dwordx4 v18, s[16:19], s99 offen offset:2048 lds
s_add_u32 m0, s55, 126976
s_add_u32 s99, s50, 6144
buffer_load_dwordx4 v16, s[16:19], s99 offen offset:0 lds
buffer_load_dwordx4 v17, s[16:19], s99 offen offset:1024 lds
buffer_load_dwordx4 v18, s[16:19], s99 offen offset:2048 lds
s_add_u32 m0, s55, 130048
s_add_u32 s99, s51, 9216
buffer_load_dwordx4 v16, s[16:19], s99 offen offset:0 lds
buffer_load_dwordx4 v17, s[16:19], s99 offen offset:1024 lds
buffer_load_dwordx4 v18, s[16:19], s99 offen offset:2048 lds
s_add_u32 m0, s55, 133120
s_add_u32 s99, s50, 24576
buffer_load_dwordx4 v16, s[16:19], s99 offen offset:0 lds
buffer_load_dwordx4 v17, s[16:19], s99 offen offset:1024 lds
buffer_load_dwordx4 v18, s[16:19], s99 offen offset:2048 lds
s_mov_b32 s20, s8
s_mov_b32 s21, s9
s_mov_b32 s22, 28311552
s_mov_b32 s23, 0x20000
v_and_b32 v208, 15, v0
v_lshrrev_b32 v24, 4, v0
v_lshrrev_b32 v210, 2, v208
v_lshl_add_u32 v210, v24, 2, v210
v_mul_u32_u24 v209, 192, v210
v_and_b32 v210, 3, v208
v_lshl_add_u32 v209, v210, 3, v209
s_mul_i32 s32, s29, 12288
s_add_u32 s32, s32, 108544
v_add_u32 v209, s32, v209
v_and_b32 v210, 1, v24
v_lshlrev_b32 v210, 5, v210
v_sub_u32 v19, v209, v210
v_add_u32 v209, v209, v210
v_and_b32 v210, 1, v208
v_lshlrev_b32 v210, 4, v210
v_mov_b32 v211, 0xffff
v_lshlrev_b32 v211, v210, v211
v_and_b32 v210, 1, v24
v_lshlrev_b32 v210, 3, v210
v_xor_b32 v210, v210, v208
v_lshrrev_b32 v210, 1, v210
v_cmp_eq_u32 vcc, 0, v210
s_nop 1
v_cndmask_b32 v20, 0, v211, vcc
v_cmp_eq_u32 vcc, 1, v210
s_nop 1
v_cndmask_b32 v21, 0, v211, vcc
v_cmp_eq_u32 vcc, 2, v210
s_nop 1
v_cndmask_b32 v22, 0, v211, vcc
v_cmp_eq_u32 vcc, 3, v210
s_nop 1
v_cndmask_b32 v23, 0, v211, vcc
v_mov_b32 v210, 0x3f803f80
v_mov_b32 v211, 0xbf80bf80
v_cmp_lt_u32 vcc, 1, v24
s_nop 1
v_cndmask_b32 v210, v210, v211, vcc
v_and_b32 v211, v210, v20
v_accvgpr_write_b32 a240, v211
v_and_b32 v211, v210, v21
v_accvgpr_write_b32 a241, v211
v_and_b32 v211, v210, v22
v_accvgpr_write_b32 a242, v211
v_and_b32 v211, v210, v23
v_accvgpr_write_b32 a243, v211
s_mul_i32 s32, s29, 3
s_sub_u32 s33, 2, s29
v_mov_b32 v210, s32
v_mov_b32 v211, s33
v_cmp_lt_u32 vcc, 1, v24
s_nop 1
v_cndmask_b32 v210, v210, v211, vcc
v_lshrrev_b32 v211, 1, v210
v_add_u32 v211, v211, v208
v_and_b32 v210, 1, v210
v_mul_u32_u24 v210, 12, v210
v_and_b32 v4, 1, v24
v_add_u32 v210, v210, v4
v_and_b32 v4, 6, v211
v_mul_u32_u24 v211, 24, v211
v_add_u32 v1, 0, v210
v_xor_b32 v1, v4, v1
v_add_lshl_u32 v1, v1, v211, 4
v_add_u32 v2, 2, v210
v_xor_b32 v2, v4, v2
v_add_lshl_u32 v2, v2, v211, 4
v_add_u32 v3, 4, v210
v_xor_b32 v3, v4, v3
v_add_lshl_u32 v3, v3, v211, 4
v_add_u32 v210, 6, v210
v_xor_b32 v4, v210, v4
v_add_lshl_u32 v4, v4, v211, 4
v_add_u32 v9, 139264, v11
v_mul_u32_u24 v212, 400, v208
v_lshl_add_u32 v212, v24, 3, v212
s_mul_i32 s32, s29, 192
v_add_u32 v212, s32, v212
s_movk_i32 s33, 2731
v_add_u32 v213, s32, v0
v_mul_u32_u24 v210, s33, v213
v_lshrrev_b32 v210, 16, v210
v_add_lshl_u32 v213, v213, v210, 4
v_add_u32 v214, s32, v0
v_add_u32 v214, 64, v214
v_mul_u32_u24 v210, s33, v214
v_lshrrev_b32 v210, 16, v210
v_add_lshl_u32 v214, v214, v210, 4
v_add_u32 v215, s32, v0
v_add_u32 v215, 128, v215
v_mul_u32_u24 v210, s33, v215
v_lshrrev_b32 v210, 16, v210
v_add_lshl_u32 v215, v215, v210, 4
s_cmp_eq_u32 s29, 0
s_cselect_b32 s52, 1.0, -1.0
s_mov_b32 s100, s52
s_mov_b32 s101, s52
s_sub_u32 s54, s34, 1
s_mul_i32 s53, s54, 73728
s_mov_b32 s54, s31
s_mul_i32 s32, s35, 6144
s_add_u32 s53, s53, s32
s_mov_b32 s57, 2.0
s_branch LpadC
.fill 304, 4, 0xbf800000
LpadC:
s_waitcnt vmcnt(9)
s_barrier
ds_read_b64_tr_b16 a[0:1], v209 offset:0
ds_read_b64_tr_b16 a[2:3], v209 offset:3072
ds_read_b64_tr_b16 a[4:5], v19 offset:32
ds_read_b64_tr_b16 a[6:7], v19 offset:3104
ds_read_b64_tr_b16 a[8:9], v209 offset:64
ds_read_b64_tr_b16 a[10:11], v209 offset:3136
ds_read_b64_tr_b16 a[12:13], v19 offset:96
ds_read_b64_tr_b16 a[14:15], v19 offset:3168
ds_read_b64_tr_b16 a[16:17], v209 offset:128
ds_read_b64_tr_b16 a[18:19], v209 offset:3200
ds_read_b64_tr_b16 a[20:21], v19 offset:160
ds_read_b64_tr_b16 a[22:23], v19 offset:3232
s_add_u32 m0, s55, 145408
s_add_u32 s99, s50, 12288
buffer_load_dwordx4 v16, s[16:19], s99 offen offset:0 lds
buffer_load_dwordx4 v17, s[16:19], s99 offen offset:1024 lds
buffer_load_dwordx4 v18, s[16:19], s99 offen offset:2048 lds
s_add_u32 m0, s55, 148480
s_add_u32 s99, s51, 15360
buffer_load_dwordx4 v16, s[16:19], s99 offen offset:0 lds
buffer_load_dwordx4 v17, s[16:19], s99 offen offset:1024 lds
buffer_load_dwordx4 v18, s[16:19], s99 offen offset:2048 lds
s_add_u32 m0, s55, 151552
s_add_u32 s99, s50, 30720
buffer_load_dwordx4 v16, s[16:19], s99 offen offset:0 lds
buffer_load_dwordx4 v17, s[16:19], s99 offen offset:1024 lds
buffer_load_dwordx4 v18, s[16:19], s99 offen offset:2048 lds
s_waitcnt vmcnt(9)
s_barrier
ds_read_b64_tr_b16 a[24:25], v209 offset:18432
ds_read_b64_tr_b16 a[26:27], v209 offset:21504
ds_read_b64_tr_b16 a[28:29], v19 offset:18464
ds_read_b64_tr_b16 a[30:31], v19 offset:21536
ds_read_b64_tr_b16 a[32:33], v209 offset:18496
ds_read_b64_tr_b16 a[34:35], v209 offset:21568
ds_read_b64_tr_b16 a[36:37], v19 offset:18528
ds_read_b64_tr_b16 a[38:39], v19 offset:21600
ds_read_b64_tr_b16 a[40:41], v209 offset:18560
ds_read_b64_tr_b16 a[42:43], v209 offset:21632
ds_read_b64_tr_b16 a[44:45], v19 offset:18592
ds_read_b64_tr_b16 a[46:47], v19 offset:21664
s_add_u32 m0, s55, 53248
s_add_u32 s99, s50, 55296
buffer_load_dwordx4 v16, s[16:19], s99 offen offset:0 lds
buffer_load_dwordx4 v17, s[16:19], s99 offen offset:1024 lds
buffer_load_dwordx4 v18, s[16:19], s99 offen offset:2048 lds
s_add_u32 m0, s55, 56320
s_add_u32 s99, s51, 58368
buffer_load_dwordx4 v16, s[16:19], s99 offen offset:0 lds
buffer_load_dwordx4 v17, s[16:19], s99 offen offset:1024 lds
buffer_load_dwordx4 v18, s[16:19], s99 offen offset:2048 lds
s_add_u32 m0, s55, 59392
s_add_u32 s99, s50, 73728
buffer_load_dwordx4 v16, s[16:19], s99 offen offset:0 lds
buffer_load_dwordx4 v17, s[16:19], s99 offen offset:1024 lds
buffer_load_dwordx4 v18, s[16:19], s99 offen offset:2048 lds
s_waitcnt vmcnt(9)
s_barrier
ds_read_b64_tr_b16 a[48:49], v209 offset:36864
ds_read_b64_tr_b16 a[50:51], v209 offset:39936
ds_read_b64_tr_b16 a[52:53], v19 offset:36896
ds_read_b64_tr_b16 a[54:55], v19 offset:39968
ds_read_b64_tr_b16 a[56:57], v209 offset:36928
ds_read_b64_tr_b16 a[58:59], v209 offset:40000
ds_read_b64_tr_b16 a[60:61], v19 offset:36960
ds_read_b64_tr_b16 a[62:63], v19 offset:40032
ds_read_b64_tr_b16 a[64:65], v209 offset:36992
ds_read_b64_tr_b16 a[66:67], v209 offset:40064
ds_read_b64_tr_b16 a[68:69], v19 offset:37024
ds_read_b64_tr_b16 a[70:71], v19 offset:40096
s_add_u32 m0, s55, 71680
s_add_u32 s99, s50, 61440
buffer_load_dwordx4 v16, s[16:19], s99 offen offset:0 lds
buffer_load_dwordx4 v17, s[16:19], s99 offen offset:1024 lds
buffer_load_dwordx4 v18, s[16:19], s99 offen offset:2048 lds
s_add_u32 m0, s55, 74752
s_add_u32 s99, s51, 64512
buffer_load_dwordx4 v16, s[16:19], s99 offen offset:0 lds
buffer_load_dwordx4 v17, s[16:19], s99 offen offset:1024 lds
buffer_load_dwordx4 v18, s[16:19], s99 offen offset:2048 lds
s_add_u32 m0, s55, 77824
s_add_u32 s99, s50, 79872
buffer_load_dwordx4 v16, s[16:19], s99 offen offset:0 lds
buffer_load_dwordx4 v17, s[16:19], s99 offen offset:1024 lds
buffer_load_dwordx4 v18, s[16:19], s99 offen offset:2048 lds
s_mov_b64 vcc, 1
s_branch LpgD0
Lpg1done:
s_mov_b64 vcc, 0
s_waitcnt vmcnt(9) lgkmcnt(0)
s_barrier
s_add_u32 m0, s55, 90112
s_add_u32 s99, s50, 67584
buffer_load_dwordx4 v16, s[16:19], s99 offen offset:0 lds
buffer_load_dwordx4 v17, s[16:19], s99 offen offset:1024 lds
buffer_load_dwordx4 v18, s[16:19], s99 offen offset:2048 lds
s_add_u32 m0, s55, 93184
s_add_u32 s99, s51, 70656
buffer_load_dwordx4 v16, s[16:19], s99 offen offset:0 lds
buffer_load_dwordx4 v17, s[16:19], s99 offen offset:1024 lds
buffer_load_dwordx4 v18, s[16:19], s99 offen offset:2048 lds
s_add_u32 m0, s55, 96256
s_add_u32 s99, s50, 86016
buffer_load_dwordx4 v16, s[16:19], s99 offen offset:0 lds
buffer_load_dwordx4 v17, s[16:19], s99 offen offset:1024 lds
buffer_load_dwordx4 v18, s[16:19], s99 offen offset:2048 lds
s_add_u32 m0, s55, 108544
s_add_u32 s99, s50, 110592
buffer_load_dwordx4 v16, s[16:19], s99 offen offset:0 lds
buffer_load_dwordx4 v17, s[16:19], s99 offen offset:1024 lds
buffer_load_dwordx4 v18, s[16:19], s99 offen offset:2048 lds
s_waitcnt vmcnt(12)
s_barrier
s_add_u32 m0, s55, 111616
s_add_u32 s99, s51, 113664
buffer_load_dwordx4 v16, s[16:19], s99 offen offset:0 lds
buffer_load_dwordx4 v17, s[16:19], s99 offen offset:1024 lds
buffer_load_dwordx4 v18, s[16:19], s99 offen offset:2048 lds
s_add_u32 m0, s55, 114688
s_add_u32 s99, s50, 129024
buffer_load_dwordx4 v16, s[16:19], s99 offen offset:0 lds
buffer_load_dwordx4 v17, s[16:19], s99 offen offset:1024 lds
buffer_load_dwordx4 v18, s[16:19], s99 offen offset:2048 lds
s_add_u32 m0, s55, 126976
s_add_u32 s99, s50, 116736
buffer_load_dwordx4 v16, s[16:19], s99 offen offset:0 lds
buffer_load_dwordx4 v17, s[16:19], s99 offen offset:1024 lds
buffer_load_dwordx4 v18, s[16:19], s99 offen offset:2048 lds
s_add_u32 m0, s55, 130048
s_add_u32 s99, s51, 119808
buffer_load_dwordx4 v16, s[16:19], s99 offen offset:0 lds
buffer_load_dwordx4 v17, s[16:19], s99 offen offset:1024 lds
buffer_load_dwordx4 v18, s[16:19], s99 offen offset:2048 lds
s_waitcnt vmcnt(15)
s_barrier
s_add_u32 m0, s55, 133120
s_add_u32 s99, s50, 135168
buffer_load_dwordx4 v16, s[16:19], s99 offen offset:0 lds
buffer_load_dwordx4 v17, s[16:19], s99 offen offset:1024 lds
buffer_load_dwordx4 v18, s[16:19], s99 offen offset:2048 lds
s_add_u32 m0, s55, 145408
s_add_u32 s99, s50, 122880
buffer_load_dwordx4 v16, s[16:19], s99 offen offset:0 lds
buffer_load_dwordx4 v17, s[16:19], s99 offen offset:1024 lds
buffer_load_dwordx4 v18, s[16:19], s99 offen offset:2048 lds
s_add_u32 m0, s55, 148480
s_add_u32 s99, s51, 125952
buffer_load_dwordx4 v16, s[16:19], s99 offen offset:0 lds
buffer_load_dwordx4 v17, s[16:19], s99 offen offset:1024 lds
buffer_load_dwordx4 v18, s[16:19], s99 offen offset:2048 lds
s_add_u32 m0, s55, 151552
s_add_u32 s99, s50, 141312
buffer_load_dwordx4 v16, s[16:19], s99 offen offset:0 lds
buffer_load_dwordx4 v17, s[16:19], s99 offen offset:1024 lds
buffer_load_dwordx4 v18, s[16:19], s99 offen offset:2048 lds
s_waitcnt vmcnt(18)
s_barrier
s_cmp_eq_u32 s39, s11
s_cselect_b32 s44, 2.0, s36
s_mov_b32 m0, s40
s_cmp_eq_u32 s38, s42
s_cselect_b32 s45, 2.0, 0
buffer_load_dwordx4 v5, s[12:15], s44 offen offset:0 nt lds
buffer_load_dwordx4 v6, s[12:15], s44 offen offset:1024 nt lds
buffer_load_dwordx4 v7, s[12:15], s44 offen offset:2048 nt lds
s_add_u32 m0, s40, s41
s_add_u32 s37, s37, 1
s_add_u32 s39, s39, 1
v_and_or_b32 v13, v12, s45, v8
buffer_load_dword v13, s[12:15], s44 offen nt lds
s_cmp_eq_u32 s37, 384
s_cselect_b32 s37, 0, s37
s_addc_u32 s38, s38, 0
s_cmp_eq_u32 s37, 0
s_cselect_b32 s49, -28231680, s48
s_add_u32 s36, s36, s49
s_add_u32 s40, s40, 6528
s_min_u32 s40, s40, s47
s_cmp_ge_u32 s39, s43
s_cselect_b32 s44, 2.0, s36
s_mov_b32 m0, s40
s_cmp_eq_u32 s38, s42
s_cselect_b32 s45, 2.0, 0
buffer_load_dwordx4 v5, s[12:15], s44 offen offset:0 nt lds
buffer_load_dwordx4 v6, s[12:15], s44 offen offset:1024 nt lds
buffer_load_dwordx4 v7, s[12:15], s44 offen offset:2048 nt lds
s_add_u32 m0, s40, s41
s_add_u32 s37, s37, 1
s_add_u32 s39, s39, 1
v_and_or_b32 v13, v12, s45, v8
buffer_load_dword v13, s[12:15], s44 offen nt lds
s_cmp_eq_u32 s37, 384
s_cselect_b32 s37, 0, s37
s_addc_u32 s38, s38, 0
s_cmp_eq_u32 s37, 0
s_cselect_b32 s49, -28231680, s48
s_add_u32 s36, s36, s49
s_add_u32 s40, s40, 6528
s_min_u32 s40, s40, s47
v_add_u32 v209, -55296, v209
v_add_u32 v19, -55296, v19
ds_read_b64_tr_b16 a[72:73], v209 offset:0
ds_read_b64_tr_b16 a[74:75], v209 offset:3072
ds_read_b64_tr_b16 a[76:77], v19 offset:32
ds_read_b64_tr_b16 a[78:79], v19 offset:3104
ds_read_b64_tr_b16 a[80:81], v209 offset:64
ds_read_b64_tr_b16 a[82:83], v209 offset:3136
ds_read_b64_tr_b16 a[84:85], v19 offset:96
ds_read_b64_tr_b16 a[86:87], v19 offset:3168
ds_read_b64_tr_b16 a[88:89], v209 offset:128
ds_read_b64_tr_b16 a[90:91], v209 offset:3200
ds_read_b64_tr_b16 a[92:93], v19 offset:160
ds_read_b64_tr_b16 a[94:95], v19 offset:3232
s_waitcnt vmcnt(17)
s_barrier
s_cmp_ge_u32 s39, s43
s_cselect_b32 s44, 2.0, s36
s_mov_b32 m0, s40
s_cmp_eq_u32 s38, s42
s_cselect_b32 s45, 2.0, 0
buffer_load_dwordx4 v5, s[12:15], s44 offen offset:0 nt lds
buffer_load_dwordx4 v6, s[12:15], s44 offen offset:1024 nt lds
buffer_load_dwordx4 v7, s[12:15], s44 offen offset:2048 nt lds
s_add_u32 m0, s40, s41
s_add_u32 s37, s37, 1
s_add_u32 s39, s39, 1
v_and_or_b32 v13, v12, s45, v8
buffer_load_dword v13, s[12:15], s44 offen nt lds
s_cmp_eq_u32 s37, 384
s_cselect_b32 s37, 0, s37
s_addc_u32 s38, s38, 0
s_cmp_eq_u32 s37, 0
s_cselect_b32 s49, -28231680, s48
s_add_u32 s36, s36, s49
s_add_u32 s40, s40, 6528
s_min_u32 s40, s40, s47
s_cmp_ge_u32 s39, s43
s_cselect_b32 s44, 2.0, s36
s_mov_b32 m0, s40
s_cmp_eq_u32 s38, s42
s_cselect_b32 s45, 2.0, 0
buffer_load_dwordx4 v5, s[12:15], s44 offen offset:0 nt lds
buffer_load_dwordx4 v6, s[12:15], s44 offen offset:1024 nt lds
buffer_load_dwordx4 v7, s[12:15], s44 offen offset:2048 nt lds
s_add_u32 m0, s40, s41
s_add_u32 s37, s37, 1
s_add_u32 s39, s39, 1
v_and_or_b32 v13, v12, s45, v8
buffer_load_dword v13, s[12:15], s44 offen nt lds
s_cmp_eq_u32 s37, 384
s_cselect_b32 s37, 0, s37
s_addc_u32 s38, s38, 0
s_cmp_eq_u32 s37, 0
s_cselect_b32 s49, -28231680, s48
s_add_u32 s36, s36, s49
s_add_u32 s40, s40, 6528
s_min_u32 s40, s40, s47
ds_read_b64_tr_b16 a[96:97], v209 offset:18432
ds_read_b64_tr_b16 a[98:99], v209 offset:21504
ds_read_b64_tr_b16 a[100:101], v19 offset:18464
ds_read_b64_tr_b16 a[102:103], v19 offset:21536
ds_read_b64_tr_b16 a[104:105], v209 offset:18496
ds_read_b64_tr_b16 a[106:107], v209 offset:21568
ds_read_b64_tr_b16 a[108:109], v19 offset:18528
ds_read_b64_tr_b16 a[110:111], v19 offset:21600
ds_read_b64_tr_b16 a[112:113], v209 offset:18560
ds_read_b64_tr_b16 a[114:115], v209 offset:21632
ds_read_b64_tr_b16 a[116:117], v19 offset:18592
ds_read_b64_tr_b16 a[118:119], v19 offset:21664
s_waitcnt vmcnt(16)
s_barrier
ds_read_b64_tr_b16 a[120:121], v209 offset:36864
ds_read_b64_tr_b16 a[122:123], v209 offset:39936
ds_read_b64_tr_b16 a[124:125], v19 offset:36896
ds_read_b64_tr_b16 a[126:127], v19 offset:39968
ds_read_b64_tr_b16 a[128:129], v209 offset:36928
ds_read_b64_tr_b16 a[130:131], v209 offset:40000
ds_read_b64_tr_b16 a[132:133], v19 offset:36960
ds_read_b64_tr_b16 a[134:135], v19 offset:40032
ds_read_b64_tr_b16 a[136:137], v209 offset:36992
ds_read_b64_tr_b16 a[138:139], v209 offset:40064
ds_read_b64_tr_b16 a[140:141], v19 offset:37024
ds_read_b64_tr_b16 a[142:143], v19 offset:40096
s_mov_b64 vcc, 1
s_cmp_eq_u32 s29, 0
s_cbranch_scc1 LpgA0
s_branch LpgB0
Lpgdone:
s_mov_b64 vcc, 0
s_cmp_lg_u32 s10, 0
s_cbranch_scc1 LwV0
s_waitcnt vmcnt(12)
LwV0:
s_barrier
ds_read_b128 a[216:219], v1 offset:0
ds_read_b128 a[220:223], v2 offset:0
ds_read_b128 a[224:227], v3 offset:0
ds_read_b128 a[228:231], v4 offset:0
ds_read_b128 a[232:235], v1 offset:128
ds_read_b128 a[236:239], v2 offset:128
s_waitcnt lgkmcnt(4)
v_mfma_f32_16x16x32_bf16 v[220:223], a[240:243], a[216:219], 0
v_add_u32 v209, 55296, v209
v_add_u32 v19, 55296, v19
v_mfma_f32_16x16x32_bf16 v[224:227], a[240:243], a[220:223], 0
ds_read_b64_tr_b16 a[144:145], v209 offset:0
s_waitcnt lgkmcnt(3)
v_mfma_f32_16x16x32_bf16 v[228:231], a[240:243], a[224:227], 0
ds_read_b64_tr_b16 a[146:147], v209 offset:3072
v_cvt_pk_bf16_f32 v28, v220, v221
v_cvt_pk_bf16_f32 v29, v222, v223
v_mfma_f32_16x16x32_bf16 v[232:235], a[240:243], a[228:231], 0
ds_read_b64_tr_b16 a[148:149], v19 offset:32
v_cvt_pk_bf16_f32 v30, v224, v225
s_waitcnt lgkmcnt(3)
v_mfma_f32_16x16x32_bf16 v[236:239], a[240:243], a[232:235], 0
ds_read_b64_tr_b16 a[150:151], v19 offset:3104
v_cvt_pk_bf16_f32 v31, v226, v227
v_cvt_pk_bf16_f32 v32, v228, v229
v_mfma_f32_16x16x32_bf16 v[240:243], a[240:243], a[236:239], 0
ds_read_b64_tr_b16 a[152:153], v209 offset:64
v_cvt_pk_bf16_f32 v33, v230, v231
v_cvt_pk_bf16_f32 v34, v232, v233
s_cmp_lg_u32 s10, 0
s_cbranch_scc1 LwV1
s_waitcnt vmcnt(8)
LwV1:
s_barrier
v_mfma_f32_16x16x32_bf16 v[112:115], a[0:3], v[28:31], 0
ds_read_b128 a[216:219], v1 offset:6528
v_cvt_pk_bf16_f32 v35, v234, v235
v_cvt_pk_bf16_f32 v36, v236, v237
s_nop 0
v_mfma_f32_16x16x32_bf16 v[112:115], a[24:27], v[32:35], v[112:115]
ds_read_b128 a[220:223], v2 offset:6528
v_cvt_pk_bf16_f32 v37, v238, v239
v_cvt_pk_bf16_f32 v38, v240, v241
v_cvt_pk_bf16_f32 v39, v242, v243
s_nop 1
v_mfma_f32_16x16x32_bf16 v[112:115], a[48:51], v[36:39], v[112:115]
ds_read_b128 a[224:227], v3 offset:6528
v_lshrrev_b32 v210, 4, v0
v_mfma_f32_16x16x32_bf16 v[116:119], a[52:55], v[36:39], 0
ds_read_b128 a[228:231], v4 offset:6528
v_add_lshl_u32 v217, v210, v0, 4
v_mfma_f32_16x16x32_bf16 v[116:119], a[28:31], v[32:35], v[116:119]
ds_read_b128 a[232:235], v1 offset:6656
s_mul_i32 s3, s29, 6656
v_mfma_f32_16x16x32_bf16 v[116:119], a[4:7], v[28:31], v[116:119]
ds_read_b128 a[236:239], v2 offset:6656
s_waitcnt lgkmcnt(4)
v_mfma_f32_16x16x32_bf16 v[220:223], a[240:243], a[216:219], 0
ds_read_b64_tr_b16 a[154:155], v209 offset:3136
v_add_u32 v1, 13056, v1
v_mfma_f32_16x16x32_bf16 v[224:227], a[240:243], a[220:223], 0
ds_read_b64_tr_b16 a[156:157], v19 offset:96
s_add_u32 s3, s3, 26368
v_mfma_f32_16x16x32_bf16 v[120:123], a[8:11], v[28:31], 0
ds_read_b64_tr_b16 a[158:159], v19 offset:3168
v_cvt_pk_bf16_f32 v40, v220, v221
v_mfma_f32_16x16x32_bf16 v[120:123], a[32:35], v[32:35], v[120:123]
ds_read_b64_tr_b16 a[160:161], v209 offset:128
v_cvt_pk_bf16_f32 v41, v222, v223
v_mfma_f32_16x16x32_bf16 v[120:123], a[56:59], v[36:39], v[120:123]
s_waitcnt lgkmcnt(6)
v_cvt_pk_bf16_f32 v42, v224, v225
v_cvt_pk_bf16_f32 v43, v226, v227
v_mfma_f32_16x16x32_bf16 v[228:231], a[240:243], a[224:227], 0
ds_read_b64_tr_b16 a[162:163], v209 offset:3200
v_add_u32 v217, s3, v217
v_mfma_f32_16x16x32_bf16 v[232:235], a[240:243], a[228:231], 0
ds_read_b64_tr_b16 a[164:165], v19 offset:160
s_mul_i32 s3, s29, 192
v_mfma_f32_16x16x32_bf16 v[124:127], a[60:63], v[36:39], 0
ds_read_b64_tr_b16 a[166:167], v19 offset:3232
v_cvt_pk_bf16_f32 v44, v228, v229
v_mfma_f32_16x16x32_bf16 v[124:127], a[36:39], v[32:35], v[124:127]
ds_read_b64_tr_b16 a[168:169], v209 offset:18432
v_cvt_pk_bf16_f32 v45, v230, v231
v_mfma_f32_16x16x32_bf16 v[124:127], a[12:15], v[28:31], v[124:127]
s_waitcnt lgkmcnt(8)
v_cvt_pk_bf16_f32 v46, v232, v233
v_cvt_pk_bf16_f32 v47, v234, v235
v_mfma_f32_16x16x32_bf16 v[236:239], a[240:243], a[232:235], 0
ds_read_b64_tr_b16 a[170:171], v209 offset:21504
v_add_u32 v10, s3, v0
v_mfma_f32_16x16x32_bf16 v[240:243], a[240:243], a[236:239], 0
ds_read_b64_tr_b16 a[172:173], v19 offset:18464
s_movk_i32 s4, 5462
v_mfma_f32_16x16x32_bf16 v[128:131], a[16:19], v[28:31], 0
ds_read_b64_tr_b16 a[174:175], v19 offset:21536
v_cvt_pk_bf16_f32 v48, v236, v237
v_mfma_f32_16x16x32_bf16 v[128:131], a[40:43], v[32:35], v[128:131]
ds_read_b64_tr_b16 a[176:177], v209 offset:18496
v_cvt_pk_bf16_f32 v49, v238, v239
v_mfma_f32_16x16x32_bf16 v[128:131], a[64:67], v[36:39], v[128:131]
ds_read_b64_tr_b16 a[178:179], v209 offset:21568
v_cvt_pk_bf16_f32 v50, v240, v241
v_mfma_f32_16x16x32_bf16 v[132:135], a[68:71], v[36:39], 0
ds_read_b64_tr_b16 a[180:181], v19 offset:18528
v_cvt_pk_bf16_f32 v51, v242, v243
v_mfma_f32_16x16x32_bf16 v[132:135], a[44:47], v[32:35], v[132:135]
ds_read_b64_tr_b16 a[182:183], v19 offset:21600
v_add_u32 v210, 0, v10
v_mfma_f32_16x16x32_bf16 v[132:135], a[20:23], v[28:31], v[132:135]
ds_read_b64_tr_b16 a[184:185], v209 offset:18560
v_mul_u32_u24 v211, s4, v210
v_mfma_f32_16x16x32_bf16 v[136:139], a[72:75], v[40:43], v[112:115]
ds_read_b64_tr_b16 a[186:187], v209 offset:21632
v_lshrrev_b32 v211, 16, v211
v_mfma_f32_16x16x32_bf16 v[136:139], a[96:99], v[44:47], v[136:139]
ds_read_b64_tr_b16 a[188:189], v19 offset:18592
v_mul_u32_u24 v25, 12, v211
s_waitcnt vmcnt(12)
s_cmp_lg_u32 s10, 0
s_cbranch_scc1 LwV2
s_waitcnt vmcnt(4)
LwV2:
s_barrier
v_mfma_f32_16x16x32_bf16 v[136:139], a[120:123], v[48:51], v[136:139]
ds_read_b128 a[216:219], v1 offset:0
v_add_u32 v2, 13056, v2
v_mfma_f32_16x16x32_bf16 v[140:143], a[124:127], v[48:51], v[116:119]
ds_read_b128 a[220:223], v2 offset:0
v_add_u32 v3, 13056, v3
v_mfma_f32_16x16x32_bf16 v[140:143], a[100:103], v[44:47], v[140:143]
ds_read_b128 a[224:227], v3 offset:0
v_add_u32 v4, 13056, v4
v_mfma_f32_16x16x32_bf16 v[140:143], a[76:79], v[40:43], v[140:143]
ds_read_b128 a[228:231], v4 offset:0
v_sub_u32 v210, v210, v25
v_mfma_f32_16x16x32_bf16 v[144:147], a[80:83], v[40:43], v[120:123]
ds_read_b64_tr_b16 a[190:191], v19 offset:21664
v_and_b32 v248, 1, v211
v_mfma_f32_16x16x32_bf16 v[144:147], a[104:107], v[44:47], v[144:147]
ds_read_b128 a[232:235], v1 offset:128
v_lshrrev_b32 v211, 1, v211
v_mfma_f32_16x16x32_bf16 v[144:147], a[128:131], v[48:51], v[144:147]
ds_read_b128 a[236:239], v2 offset:128
v_lshlrev_b32 v252, 31, v248
v_mfma_f32_16x16x32_bf16 v[148:151], a[132:135], v[48:51], v[124:127]
ds_read_b64_tr_b16 a[192:193], v209 offset:36864
v_or_b32 v252, 1.0, v252
v_mfma_f32_16x16x32_bf16 v[148:151], a[108:111], v[44:47], v[148:151]
ds_read_b64_tr_b16 a[194:195], v209 offset:39936
v_lshrrev_b32 v25, 1, v210
v_mfma_f32_16x16x32_bf16 v[148:151], a[84:87], v[40:43], v[148:151]
ds_read_b64_tr_b16 a[196:197], v19 offset:36896
s_waitcnt lgkmcnt(8)
v_mfma_f32_16x16x32_bf16 v[220:223], a[240:243], a[216:219], 0
ds_read_b64_tr_b16 a[198:199], v19 offset:39968
v_mul_u32_u24 v25, 69, v25
v_mfma_f32_16x16x32_bf16 v[224:227], a[240:243], a[220:223], 0
ds_read_b64_tr_b16 a[200:201], v209 offset:36928
v_add_u32 v211, v211, v25
v_mfma_f32_16x16x32_bf16 v[152:155], a[88:91], v[40:43], v[128:131]
ds_read_b64_tr_b16 a[202:203], v209 offset:40000
v_cvt_pk_bf16_f32 v28, v220, v221
v_mfma_f32_16x16x32_bf16 v[152:155], a[112:115], v[44:47], v[152:155]
ds_read_b64_tr_b16 a[204:205], v19 offset:36960
v_cvt_pk_bf16_f32 v29, v222, v223
v_mfma_f32_16x16x32_bf16 v[152:155], a[136:139], v[48:51], v[152:155]
ds_read_b64_tr_b16 a[206:207], v19 offset:40032
s_waitcnt lgkmcnt(11)
v_mfma_f32_16x16x32_bf16 v[228:231], a[240:243], a[224:227], 0
ds_read_b64_tr_b16 a[208:209], v209 offset:36992
v_cvt_pk_bf16_f32 v30, v224, v225
v_mfma_f32_16x16x32_bf16 v[232:235], a[240:243], a[228:231], 0
ds_read_b64_tr_b16 a[210:211], v209 offset:40064
v_cvt_pk_bf16_f32 v31, v226, v227
v_mfma_f32_16x16x32_bf16 v[156:159], a[140:143], v[48:51], v[132:135]
ds_read_b64_tr_b16 a[212:213], v19 offset:37024
v_cvt_pk_bf16_f32 v32, v228, v229
v_mfma_f32_16x16x32_bf16 v[156:159], a[116:119], v[44:47], v[156:159]
ds_read_b64_tr_b16 a[214:215], v19 offset:40096
v_cvt_pk_bf16_f32 v33, v230, v231
v_mfma_f32_16x16x32_bf16 v[156:159], a[92:95], v[40:43], v[156:159]
s_waitcnt lgkmcnt(12)
v_cvt_pk_bf16_f32 v34, v232, v233
v_cvt_pk_bf16_f32 v35, v234, v235
v_mfma_f32_16x16x32_bf16 v[236:239], a[240:243], a[232:235], 0
v_and_b32 v210, 1, v210
v_mul_u32_u24 v210, 34, v210
v_mfma_f32_16x16x32_bf16 v[240:243], a[240:243], a[236:239], 0
v_add_lshl_u32 v25, v210, v211, 4
v_mul_u32_u24 v248, 6656, v248
v_mfma_f32_16x16x32_bf16 v[112:115], a[0:3], v[40:43], 0
v_add_u32 v248, v248, v25
v_cvt_pk_bf16_f32 v36, v236, v237
v_mfma_f32_16x16x32_bf16 v[112:115], a[24:27], v[44:47], v[112:115]
v_cvt_pk_bf16_f32 v37, v238, v239
v_cvt_pk_bf16_f32 v38, v240, v241
v_mfma_f32_16x16x32_bf16 v[112:115], a[48:51], v[48:51], v[112:115]
v_cvt_pk_bf16_f32 v39, v242, v243
v_add_u32 v210, 64, v10
v_mfma_f32_16x16x32_bf16 v[116:119], a[52:55], v[48:51], 0
v_mul_u32_u24 v211, s4, v210
v_lshrrev_b32 v211, 16, v211
v_mfma_f32_16x16x32_bf16 v[116:119], a[28:31], v[44:47], v[116:119]
v_mul_u32_u24 v26, 12, v211
v_sub_u32 v210, v210, v26
v_mfma_f32_16x16x32_bf16 v[116:119], a[4:7], v[40:43], v[116:119]
v_and_b32 v249, 1, v211
v_lshrrev_b32 v211, 1, v211
v_mfma_f32_16x16x32_bf16 v[120:123], a[8:11], v[40:43], 0
v_lshlrev_b32 v254, 31, v249
v_or_b32 v254, 1.0, v254
v_mfma_f32_16x16x32_bf16 v[120:123], a[32:35], v[44:47], v[120:123]
v_lshrrev_b32 v26, 1, v210
v_mul_u32_u24 v26, 69, v26
v_mfma_f32_16x16x32_bf16 v[120:123], a[56:59], v[48:51], v[120:123]
v_add_u32 v211, v211, v26
v_and_b32 v210, 1, v210
v_mfma_f32_16x16x32_bf16 v[124:127], a[60:63], v[48:51], 0
v_mul_u32_u24 v210, 34, v210
v_add_lshl_u32 v26, v210, v211, 4
v_mfma_f32_16x16x32_bf16 v[124:127], a[36:39], v[44:47], v[124:127]
v_mul_u32_u24 v249, 6656, v249
v_add_u32 v249, v249, v26
v_mfma_f32_16x16x32_bf16 v[124:127], a[12:15], v[40:43], v[124:127]
v_add_u32 v210, 128, v10
v_mul_u32_u24 v211, s4, v210
v_mfma_f32_16x16x32_bf16 v[128:131], a[16:19], v[40:43], 0
v_lshrrev_b32 v211, 16, v211
v_mul_u32_u24 v27, 12, v211
v_mfma_f32_16x16x32_bf16 v[128:131], a[40:43], v[44:47], v[128:131]
v_sub_u32 v210, v210, v27
v_and_b32 v250, 1, v211
v_mfma_f32_16x16x32_bf16 v[128:131], a[64:67], v[48:51], v[128:131]
v_lshrrev_b32 v211, 1, v211
v_lshlrev_b32 v218, 31, v250
v_mfma_f32_16x16x32_bf16 v[132:135], a[68:71], v[48:51], 0
v_or_b32 v218, 1.0, v218
v_lshrrev_b32 v27, 1, v210
v_mfma_f32_16x16x32_bf16 v[132:135], a[44:47], v[44:47], v[132:135]
v_mul_u32_u24 v27, 69, v27
v_add_u32 v211, v211, v27
v_mfma_f32_16x16x32_bf16 v[132:135], a[20:23], v[40:43], v[132:135]
v_and_b32 v210, 1, v210
v_mul_u32_u24 v210, 34, v210
v_add_lshl_u32 v27, v210, v211, 4
v_mul_u32_u24 v250, 6656, v250
v_add_u32 v250, v250, v27
v_lshlrev_b32 v10, 4, v10
s_waitcnt vmcnt(0) lgkmcnt(0)
s_barrier
s_mov_b32 s46, 2
.p2align 6, , 60
s_nop 0
LC_loop:
v_mfma_f32_16x16x32_bf16 v[160:163], a[144:147], v[28:31], v[136:139]
ds_read_b128 v[68:71], v9 offset:16384
v_add_f32 v60, v192, v60
v_mfma_f32_16x16x32_bf16 v[160:163], a[168:171], v[32:35], v[160:163]
ds_read_b128 v[92:95], v9 offset:22528
v_add_f32 v61, v193, v61
v_mfma_f32_16x16x32_bf16 v[160:163], a[192:195], v[36:39], v[160:163]
v_add_f32 v62, v194, v62
v_add_f32 v63, v195, v63
v_mfma_f32_16x16x32_bf16 v[164:167], a[196:199], v[36:39], v[140:143]
ds_read_b128 a[216:219], v1 offset:6528
v_fma_f32 v60, v84, s52, v60
v_mfma_f32_16x16x32_bf16 v[164:167], a[172:175], v[32:35], v[164:167]
ds_read_b128 a[220:223], v2 offset:6528
v_fma_f32 v61, v85, s52, v61
v_mfma_f32_16x16x32_bf16 v[164:167], a[148:151], v[28:31], v[164:167]
ds_read_b128 v[72:75], v9 offset:17408
v_fma_f32 v62, v86, s52, v62
v_mfma_f32_16x16x32_bf16 v[168:171], a[152:155], v[28:31], v[144:147]
s_waitcnt lgkmcnt(6)
v_fma_f32 v63, v87, s52, v63
v_cvt_pk_bf16_f32 v244, v60, v61
v_mfma_f32_16x16x32_bf16 v[168:171], a[176:179], v[32:35], v[168:171]
ds_read_b128 v[96:99], v9 offset:23552
v_cvt_pk_bf16_f32 v245, v62, v63
v_mfma_f32_16x16x32_bf16 v[168:171], a[200:203], v[36:39], v[168:171]
ds_write_b64 v212, v[244:245] offset:6592
v_mfma_f32_16x16x32_bf16 v[172:175], a[204:207], v[36:39], v[148:151]
ds_read_b128 a[224:227], v3 offset:6528
v_add_f32 v64, v196, v64
v_mfma_f32_16x16x32_bf16 v[172:175], a[180:183], v[32:35], v[172:175]
ds_read_b128 a[228:231], v4 offset:6528
v_add_f32 v65, v197, v65
v_mfma_f32_16x16x32_bf16 v[172:175], a[156:159], v[28:31], v[172:175]
v_add_f32 v66, v198, v66
v_add_f32 v67, v199, v67
v_mfma_f32_16x16x32_bf16 v[176:179], a[160:163], v[28:31], v[152:155]
v_fma_f32 v64, v88, s52, v64
v_fma_f32 v65, v89, s52, v65
v_mfma_f32_16x16x32_bf16 v[176:179], a[184:187], v[32:35], v[176:179]
ds_read_b128 a[232:235], v1 offset:6656
v_fma_f32 v66, v90, s52, v66
v_mfma_f32_16x16x32_bf16 v[176:179], a[208:211], v[36:39], v[176:179]
ds_read_b128 a[236:239], v2 offset:6656
v_fma_f32 v67, v91, s52, v67
v_mfma_f32_16x16x32_bf16 v[180:183], a[212:215], v[36:39], v[156:159]
s_waitcnt lgkmcnt(9)
v_cvt_pk_bf16_f32 v246, v64, v65
v_cvt_pk_bf16_f32 v247, v66, v67
v_mfma_f32_16x16x32_bf16 v[180:183], a[188:191], v[32:35], v[180:183]
ds_write_b64 v212, v[246:247] offset:6624
v_mfma_f32_16x16x32_bf16 v[180:183], a[164:167], v[28:31], v[180:183]
s_waitcnt lgkmcnt(8)
v_add_f32 v68, v200, v68
v_add_f32 v69, v201, v69
v_mfma_f32_16x16x32_bf16 v[220:223], a[240:243], a[216:219], 0
v_add_f32 v70, v202, v70
v_add_f32 v71, v203, v71
v_mfma_f32_16x16x32_bf16 v[224:227], a[240:243], a[220:223], 0
v_fma_f32 v68, v92, s52, v68
v_fma_f32 v69, v93, s52, v69
v_mfma_f32_16x16x32_bf16 v[136:139], a[72:75], v[28:31], v[112:115]
s_waitcnt lgkmcnt(6)
v_fma_f32 v70, v94, s52, v70
v_fma_f32 v71, v95, s52, v71
v_mfma_f32_16x16x32_bf16 v[136:139], a[96:99], v[32:35], v[136:139]
v_cvt_pk_bf16_f32 v244, v68, v69
v_cvt_pk_bf16_f32 v245, v70, v71
v_mfma_f32_16x16x32_bf16 v[136:139], a[120:123], v[36:39], v[136:139]
s_waitcnt lgkmcnt(3)
v_add_f32 v72, v204, v72
v_add_f32 v73, v205, v73
v_mfma_f32_16x16x32_bf16 v[228:231], a[240:243], a[224:227], 0
ds_write_b64 v212, v[244:245] offset:6656
v_mfma_f32_16x16x32_bf16 v[232:235], a[240:243], a[228:231], 0
v_add_f32 v74, v206, v74
v_add_f32 v75, v207, v75
v_mfma_f32_16x16x32_bf16 v[140:143], a[124:127], v[36:39], v[116:119]
v_fma_f32 v72, v96, s52, v72
v_fma_f32 v73, v97, s52, v73
v_mfma_f32_16x16x32_bf16 v[140:143], a[100:103], v[32:35], v[140:143]
v_fma_f32 v74, v98, s52, v74
v_fma_f32 v75, v99, s52, v75
v_mfma_f32_16x16x32_bf16 v[140:143], a[76:79], v[28:31], v[140:143]
s_waitcnt lgkmcnt(2)
v_cvt_pk_bf16_f32 v246, v72, v73
v_cvt_pk_bf16_f32 v247, v74, v75
v_mfma_f32_16x16x32_bf16 v[236:239], a[240:243], a[232:235], 0
ds_write_b64 v212, v[246:247] offset:6688
v_mfma_f32_16x16x32_bf16 v[240:243], a[240:243], a[236:239], 0
v_cvt_pk_bf16_f32 v40, v220, v221
v_cvt_pk_bf16_f32 v41, v222, v223
v_mfma_f32_16x16x32_bf16 v[144:147], a[80:83], v[28:31], v[120:123]
v_cvt_pk_bf16_f32 v42, v224, v225
v_cvt_pk_bf16_f32 v43, v226, v227
v_mfma_f32_16x16x32_bf16 v[144:147], a[104:107], v[32:35], v[144:147]
v_cvt_pk_bf16_f32 v44, v228, v229
v_cvt_pk_bf16_f32 v45, v230, v231
v_mfma_f32_16x16x32_bf16 v[144:147], a[128:131], v[36:39], v[144:147]
v_cvt_pk_bf16_f32 v46, v232, v233
v_cvt_pk_bf16_f32 v47, v234, v235
v_mfma_f32_16x16x32_bf16 v[148:151], a[132:135], v[36:39], v[124:127]
v_cvt_pk_bf16_f32 v48, v236, v237
v_cvt_pk_bf16_f32 v49, v238, v239
v_mfma_f32_16x16x32_bf16 v[148:151], a[108:111], v[32:35], v[148:151]
v_cvt_pk_bf16_f32 v50, v240, v241
v_cvt_pk_bf16_f32 v51, v242, v243
v_mfma_f32_16x16x32_bf16 v[148:151], a[84:87], v[28:31], v[148:151]
s_waitcnt lgkmcnt(0)
s_barrier
v_add_u32 v1, 13056, v1
v_mfma_f32_16x16x32_bf16 v[152:155], a[88:91], v[28:31], v[128:131]
ds_read_b128 v[52:55], v9 offset:0
s_mov_b32 s56, s57
v_mfma_f32_16x16x32_bf16 v[152:155], a[112:115], v[32:35], v[152:155]
ds_read_b128 v[76:79], v9 offset:6144
s_add_u32 s53, s53, s48
v_mfma_f32_16x16x32_bf16 v[152:155], a[136:139], v[36:39], v[152:155]
ds_read_b128 v[56:59], v9 offset:1024
s_sub_u32 s54, s54, 1
v_mfma_f32_16x16x32_bf16 v[156:159], a[140:143], v[36:39], v[132:135]
ds_read_b128 v[80:83], v9 offset:7168
s_cselect_b32 s32, -28305408, 0
v_mfma_f32_16x16x32_bf16 v[156:159], a[116:119], v[32:35], v[156:159]
ds_read_b128 v[100:103], v213 offset:6528
s_add_u32 s53, s53, s32
v_mfma_f32_16x16x32_bf16 v[156:159], a[92:95], v[28:31], v[156:159]
ds_read_b128 v[104:107], v214 offset:6528
s_mov_b32 s57, s53
v_mfma_f32_16x16x32_bf16 v[112:115], a[0:3], v[28:31], 0
ds_read_b128 v[108:111], v215 offset:6528
s_waitcnt lgkmcnt(5)
v_mfma_f32_16x16x32_bf16 v[112:115], a[24:27], v[32:35], v[112:115]
v_add_f32 v52, v160, v52
v_add_f32 v53, v161, v53
v_mfma_f32_16x16x32_bf16 v[112:115], a[48:51], v[36:39], v[112:115]
ds_read_b128 v[60:63], v9 offset:2048
v_add_f32 v54, v162, v54
v_mfma_f32_16x16x32_bf16 v[116:119], a[52:55], v[36:39], 0
v_add_f32 v55, v163, v55
v_fma_f32 v52, v76, s52, v52
v_mfma_f32_16x16x32_bf16 v[116:119], a[28:31], v[32:35], v[116:119]
ds_read_b128 v[84:87], v9 offset:8192
v_fma_f32 v53, v77, s52, v53
v_mfma_f32_16x16x32_bf16 v[116:119], a[4:7], v[28:31], v[116:119]
s_waitcnt lgkmcnt(4)
v_fma_f32 v54, v78, s52, v54
v_fma_f32 v55, v79, s52, v55
v_mfma_f32_16x16x32_bf16 v[120:123], a[8:11], v[28:31], 0
v_cvt_pk_bf16_f32 v244, v52, v53
v_cvt_pk_bf16_f32 v245, v54, v55
v_mfma_f32_16x16x32_bf16 v[120:123], a[32:35], v[32:35], v[120:123]
ds_write_b64 v212, v[244:245] offset:0
v_mfma_f32_16x16x32_bf16 v[120:123], a[56:59], v[36:39], v[120:123]
buffer_store_dwordx4 v[100:103], v10, s[20:23], s56 offen offset:0 sc1
v_mfma_f32_16x16x32_bf16 v[124:127], a[60:63], v[36:39], 0
ds_read_b128 v[64:67], v9 offset:3072
v_add_f32 v56, v164, v56
v_mfma_f32_16x16x32_bf16 v[124:127], a[36:39], v[32:35], v[124:127]
s_waitcnt lgkmcnt(5)
v_add_f32 v57, v165, v57
v_add_f32 v58, v166, v58
v_mfma_f32_16x16x32_bf16 v[124:127], a[12:15], v[28:31], v[124:127]
ds_read_b128 v[88:91], v9 offset:9216
v_add_f32 v59, v167, v59
v_mfma_f32_16x16x32_bf16 v[128:131], a[16:19], v[28:31], 0
buffer_store_dwordx4 v[104:107], v10, s[20:23], s56 offen offset:1024 sc1
v_mfma_f32_16x16x32_bf16 v[128:131], a[40:43], v[32:35], v[128:131]
s_waitcnt lgkmcnt(5)
v_fma_f32 v56, v80, s52, v56
v_fma_f32 v57, v81, s52, v57
v_mfma_f32_16x16x32_bf16 v[128:131], a[64:67], v[36:39], v[128:131]
s_waitcnt lgkmcnt(3)
v_fma_f32 v58, v82, s52, v58
v_fma_f32 v59, v83, s52, v59
v_mfma_f32_16x16x32_bf16 v[132:135], a[68:71], v[36:39], 0
v_cvt_pk_bf16_f32 v246, v56, v57
v_cvt_pk_bf16_f32 v247, v58, v59
v_mfma_f32_16x16x32_bf16 v[132:135], a[44:47], v[32:35], v[132:135]
ds_write_b64 v212, v[246:247] offset:32
v_mfma_f32_16x16x32_bf16 v[132:135], a[20:23], v[28:31], v[132:135]
buffer_store_dwordx4 v[108:111], v10, s[20:23], s56 offen offset:2048 sc1
v_mfma_f32_16x16x32_bf16 v[184:187], a[144:147], v[40:43], v[136:139]
ds_read_b128 v[68:71], v9 offset:4096
v_add_f32 v60, v168, v60
v_mfma_f32_16x16x32_bf16 v[184:187], a[168:171], v[44:47], v[184:187]
ds_read_b128 v[92:95], v9 offset:10240
v_add_f32 v61, v169, v61
v_mfma_f32_16x16x32_bf16 v[184:187], a[192:195], v[48:51], v[184:187]
v_add_f32 v62, v170, v62
v_add_f32 v63, v171, v63
v_mfma_f32_16x16x32_bf16 v[188:191], a[196:199], v[48:51], v[140:143]
ds_read_b128 a[216:219], v1 offset:0
v_fma_f32 v60, v84, s52, v60
v_mfma_f32_16x16x32_bf16 v[188:191], a[172:175], v[44:47], v[188:191]
v_fma_f32 v61, v85, s52, v61
v_fma_f32 v62, v86, s52, v62
v_mfma_f32_16x16x32_bf16 v[188:191], a[148:151], v[40:43], v[188:191]
ds_read_b128 v[72:75], v9 offset:5120
v_fma_f32 v63, v87, s52, v63
v_mfma_f32_16x16x32_bf16 v[192:195], a[152:155], v[40:43], v[144:147]
s_waitcnt lgkmcnt(5)
v_cvt_pk_bf16_f32 v244, v60, v61
v_cvt_pk_bf16_f32 v245, v62, v63
v_mfma_f32_16x16x32_bf16 v[192:195], a[176:179], v[44:47], v[192:195]
ds_write_b64 v212, v[244:245] offset:64
v_mfma_f32_16x16x32_bf16 v[192:195], a[200:203], v[48:51], v[192:195]
ds_read_b128 v[96:99], v9 offset:11264
v_add_f32 v64, v172, v64
v_mfma_f32_16x16x32_bf16 v[196:199], a[204:207], v[48:51], v[148:151]
v_add_f32 v65, v173, v65
v_add_f32 v66, v174, v66
v_mfma_f32_16x16x32_bf16 v[196:199], a[180:183], v[44:47], v[196:199]
v_add_f32 v67, v175, v67
v_fma_f32 v64, v88, s52, v64
v_mfma_f32_16x16x32_bf16 v[196:199], a[156:159], v[40:43], v[196:199]
v_fma_f32 v65, v89, s52, v65
v_fma_f32 v66, v90, s52, v66
v_mfma_f32_16x16x32_bf16 v[200:203], a[160:163], v[40:43], v[152:155]
s_waitcnt lgkmcnt(4)
v_add_u32 v2, 13056, v2
v_fma_f32 v67, v91, s52, v67
v_mfma_f32_16x16x32_bf16 v[200:203], a[184:187], v[44:47], v[200:203]
ds_read_b128 a[220:223], v2 offset:0
v_cvt_pk_bf16_f32 v246, v64, v65
v_mfma_f32_16x16x32_bf16 v[200:203], a[208:211], v[48:51], v[200:203]
v_cvt_pk_bf16_f32 v247, v66, v67
v_add_f32 v68, v176, v68
v_mfma_f32_16x16x32_bf16 v[204:207], a[212:215], v[48:51], v[156:159]
ds_write_b64 v212, v[246:247] offset:96
v_mfma_f32_16x16x32_bf16 v[204:207], a[188:191], v[44:47], v[204:207]
s_cmp_eq_u32 s46, s31
v_add_f32 v69, v177, v69
v_add_u32 v3, 13056, v3
v_mfma_f32_16x16x32_bf16 v[204:207], a[164:167], v[40:43], v[204:207]
s_cbranch_scc1 LC_seam
LC_back:
v_add_f32 v70, v178, v70
v_add_f32 v71, v179, v71
s_waitcnt lgkmcnt(1)
v_mfma_f32_16x16x32_bf16 v[220:223], a[240:243], a[216:219], 0
ds_read_b128 a[224:227], v3 offset:0
v_add_u32 v4, 13056, v4
v_mfma_f32_16x16x32_bf16 v[224:227], a[240:243], a[220:223], 0
ds_read_b128 a[228:231], v4 offset:0
v_fma_f32 v68, v92, s52, v68
v_mfma_f32_16x16x32_bf16 v[136:139], a[72:75], v[40:43], v[112:115]
ds_read_b128 a[232:235], v1 offset:128
v_fma_f32 v69, v93, s52, v69
v_mfma_f32_16x16x32_bf16 v[136:139], a[96:99], v[44:47], v[136:139]
ds_read_b128 a[236:239], v2 offset:128
v_fma_f32 v70, v94, s52, v70
v_mfma_f32_16x16x32_bf16 v[136:139], a[120:123], v[48:51], v[136:139]
s_waitcnt lgkmcnt(2)
v_fma_f32 v71, v95, s52, v71
v_cvt_pk_bf16_f32 v244, v68, v69
v_mfma_f32_16x16x32_bf16 v[228:231], a[240:243], a[224:227], 0
v_cvt_pk_bf16_f32 v245, v70, v71
v_add_f32 v72, v180, v72
v_mfma_f32_16x16x32_bf16 v[232:235], a[240:243], a[228:231], 0
ds_write_b64 v212, v[244:245] offset:128
v_mfma_f32_16x16x32_bf16 v[140:143], a[124:127], v[48:51], v[116:119]
v_add_f32 v73, v181, v73
v_add_f32 v74, v182, v74
v_mfma_f32_16x16x32_bf16 v[140:143], a[100:103], v[44:47], v[140:143]
v_add_f32 v75, v183, v75
v_fma_f32 v72, v96, s52, v72
v_mfma_f32_16x16x32_bf16 v[140:143], a[76:79], v[40:43], v[140:143]
s_waitcnt lgkmcnt(1)
v_fma_f32 v73, v97, s52, v73
v_fma_f32 v74, v98, s52, v74
v_mfma_f32_16x16x32_bf16 v[236:239], a[240:243], a[232:235], 0
v_fma_f32 v75, v99, s52, v75
v_cvt_pk_bf16_f32 v246, v72, v73
v_mfma_f32_16x16x32_bf16 v[240:243], a[240:243], a[236:239], 0
v_cvt_pk_bf16_f32 v247, v74, v75
v_cvt_pk_bf16_f32 v28, v220, v221
v_mfma_f32_16x16x32_bf16 v[144:147], a[80:83], v[40:43], v[120:123]
ds_write_b64 v212, v[246:247] offset:160
v_mfma_f32_16x16x32_bf16 v[144:147], a[104:107], v[44:47], v[144:147]
v_cvt_pk_bf16_f32 v29, v222, v223
v_cvt_pk_bf16_f32 v30, v224, v225
v_mfma_f32_16x16x32_bf16 v[144:147], a[128:131], v[48:51], v[144:147]
v_cvt_pk_bf16_f32 v31, v226, v227
v_cvt_pk_bf16_f32 v32, v228, v229
v_mfma_f32_16x16x32_bf16 v[148:151], a[132:135], v[48:51], v[124:127]
v_cvt_pk_bf16_f32 v33, v230, v231
v_cvt_pk_bf16_f32 v34, v232, v233
v_mfma_f32_16x16x32_bf16 v[148:151], a[108:111], v[44:47], v[148:151]
v_cvt_pk_bf16_f32 v35, v234, v235
v_cvt_pk_bf16_f32 v36, v236, v237
v_mfma_f32_16x16x32_bf16 v[148:151], a[84:87], v[40:43], v[148:151]
s_waitcnt lgkmcnt(0)
s_barrier
v_cvt_pk_bf16_f32 v37, v238, v239
v_cvt_pk_bf16_f32 v38, v240, v241
v_mfma_f32_16x16x32_bf16 v[152:155], a[88:91], v[40:43], v[128:131]
ds_read_b128 v[52:55], v9 offset:12288
v_cvt_pk_bf16_f32 v39, v242, v243
v_mfma_f32_16x16x32_bf16 v[152:155], a[112:115], v[44:47], v[152:155]
s_mov_b32 s56, s57
ds_read_b128 v[76:79], v9 offset:18432
v_mfma_f32_16x16x32_bf16 v[152:155], a[136:139], v[48:51], v[152:155]
s_add_u32 s53, s53, s48
ds_read_b128 v[56:59], v9 offset:13312
v_mfma_f32_16x16x32_bf16 v[156:159], a[140:143], v[48:51], v[132:135]
s_sub_u32 s54, s54, 1
ds_read_b128 v[80:83], v9 offset:19456
v_mfma_f32_16x16x32_bf16 v[156:159], a[116:119], v[44:47], v[156:159]
s_cselect_b32 s32, -28305408, 0
ds_read_b128 v[100:103], v213 offset:0
v_mfma_f32_16x16x32_bf16 v[156:159], a[92:95], v[40:43], v[156:159]
s_add_u32 s53, s53, s32
ds_read_b128 v[104:107], v214 offset:0
v_mfma_f32_16x16x32_bf16 v[112:115], a[0:3], v[40:43], 0
s_mov_b32 s57, s53
ds_read_b128 v[108:111], v215 offset:0
v_mfma_f32_16x16x32_bf16 v[112:115], a[24:27], v[44:47], v[112:115]
s_waitcnt lgkmcnt(5)
v_add_f32 v52, v184, v52
v_add_f32 v53, v185, v53
v_mfma_f32_16x16x32_bf16 v[112:115], a[48:51], v[48:51], v[112:115]
ds_read_b128 v[60:63], v9 offset:14336
v_add_f32 v54, v186, v54
v_mfma_f32_16x16x32_bf16 v[116:119], a[52:55], v[48:51], 0
v_add_f32 v55, v187, v55
v_fma_f32 v52, v76, s52, v52
v_mfma_f32_16x16x32_bf16 v[116:119], a[28:31], v[44:47], v[116:119]
LpgA0:
s_cbranch_vccnz Lpgdone
ds_read_b128 v[84:87], v9 offset:20480
v_fma_f32 v53, v77, s52, v53
v_mfma_f32_16x16x32_bf16 v[116:119], a[4:7], v[40:43], v[116:119]
s_waitcnt lgkmcnt(4)
v_fma_f32 v54, v78, s52, v54
v_fma_f32 v55, v79, s52, v55
v_mfma_f32_16x16x32_bf16 v[120:123], a[8:11], v[40:43], 0
s_add_u32 s46, s46, 2
v_cvt_pk_bf16_f32 v244, v52, v53
v_cvt_pk_bf16_f32 v245, v54, v55
v_mfma_f32_16x16x32_bf16 v[120:123], a[32:35], v[44:47], v[120:123]
ds_write_b64 v212, v[244:245] offset:6528
v_mfma_f32_16x16x32_bf16 v[120:123], a[56:59], v[48:51], v[120:123]
buffer_store_dwordx4 v[100:103], v10, s[20:23], s56 offen offset:0 sc1
v_mfma_f32_16x16x32_bf16 v[124:127], a[60:63], v[48:51], 0
ds_read_b128 v[64:67], v9 offset:15360
v_add_f32 v56, v188, v56
v_mfma_f32_16x16x32_bf16 v[124:127], a[36:39], v[44:47], v[124:127]
s_waitcnt lgkmcnt(5)
v_add_f32 v57, v189, v57
v_add_f32 v58, v190, v58
v_mfma_f32_16x16x32_bf16 v[124:127], a[12:15], v[40:43], v[124:127]
ds_read_b128 v[88:91], v9 offset:21504
v_add_f32 v59, v191, v59
v_mfma_f32_16x16x32_bf16 v[128:131], a[16:19], v[40:43], 0
buffer_store_dwordx4 v[104:107], v10, s[20:23], s56 offen offset:1024 sc1
v_mfma_f32_16x16x32_bf16 v[128:131], a[40:43], v[44:47], v[128:131]
s_waitcnt lgkmcnt(5)
v_fma_f32 v56, v80, s52, v56
v_fma_f32 v57, v81, s52, v57
v_mfma_f32_16x16x32_bf16 v[128:131], a[64:67], v[48:51], v[128:131]
s_waitcnt lgkmcnt(3)
v_fma_f32 v58, v82, s52, v58
v_fma_f32 v59, v83, s52, v59
v_mfma_f32_16x16x32_bf16 v[132:135], a[68:71], v[48:51], 0
s_cmp_lt_u32 s46, 18
v_cvt_pk_bf16_f32 v246, v56, v57
v_cvt_pk_bf16_f32 v247, v58, v59
v_mfma_f32_16x16x32_bf16 v[132:135], a[44:47], v[44:47], v[132:135]
ds_write_b64 v212, v[246:247] offset:6560
v_mfma_f32_16x16x32_bf16 v[132:135], a[20:23], v[40:43], v[132:135]
buffer_store_dwordx4 v[108:111], v10, s[20:23], s56 offen offset:2048 sc1
s_cbranch_scc1 LC_loop
s_branch LC_exit
LC_seam:
v_mfma_f32_16x16x32_bf16 v[184:187], a[244:247], a[244:247], v[136:139]
v_mov_b32 v112, 0
v_mov_b32 v113, 0
v_mov_b32 v114, 0
v_mov_b32 v115, 0
v_mfma_f32_16x16x32_bf16 v[188:191], a[244:247], a[244:247], v[140:143]
v_mov_b32 v116, 0
v_mov_b32 v117, 0
v_mov_b32 v118, 0
v_mov_b32 v119, 0
v_mfma_f32_16x16x32_bf16 v[192:195], a[244:247], a[244:247], v[144:147]
v_mov_b32 v120, 0
v_mov_b32 v121, 0
v_mov_b32 v122, 0
v_mov_b32 v123, 0
v_mfma_f32_16x16x32_bf16 v[196:199], a[244:247], a[244:247], v[148:151]
v_mov_b32 v124, 0
v_mov_b32 v125, 0
v_mov_b32 v126, 0
v_mov_b32 v127, 0
v_mfma_f32_16x16x32_bf16 v[200:203], a[244:247], a[244:247], v[152:155]
v_mov_b32 v128, 0
v_mov_b32 v129, 0
v_mov_b32 v130, 0
v_mov_b32 v131, 0
v_mfma_f32_16x16x32_bf16 v[204:207], a[244:247], a[244:247], v[156:159]
v_mov_b32 v132, 0
v_mov_b32 v133, 0
v_mov_b32 v134, 0
v_mov_b32 v135, 0
s_nop 0
s_branch LC_back
LC_exit:
v_mfma_f32_16x16x32_bf16 v[160:163], a[144:147], v[28:31], v[136:139]
ds_read_b128 v[68:71], v9 offset:16384
v_add_f32 v60, v192, v60
v_mfma_f32_16x16x32_bf16 v[160:163], a[168:171], v[32:35], v[160:163]
ds_read_b128 a[216:219], v1 offset:6528
v_add_f32 v61, v193, v61
v_mfma_f32_16x16x32_bf16 v[160:163], a[192:195], v[36:39], v[160:163]
ds_read_b128 v[92:95], v9 offset:22528
v_add_f32 v62, v194, v62
v_mfma_f32_16x16x32_bf16 v[164:167], a[196:199], v[36:39], v[140:143]
ds_read_b128 a[220:223], v2 offset:6528
v_add_f32 v63, v195, v63
v_mfma_f32_16x16x32_bf16 v[164:167], a[172:175], v[32:35], v[164:167]
ds_read_b128 a[224:227], v3 offset:6528
v_fma_f32 v60, v84, s52, v60
v_mfma_f32_16x16x32_bf16 v[164:167], a[148:151], v[28:31], v[164:167]
ds_write_b128 v217, v[160:163] offset:0
v_mfma_f32_16x16x32_bf16 v[168:171], a[152:155], v[28:31], v[144:147]
ds_read_b128 v[72:75], v9 offset:17408
v_fma_f32 v61, v85, s52, v61
v_mfma_f32_16x16x32_bf16 v[168:171], a[176:179], v[32:35], v[168:171]
ds_read_b128 a[228:231], v4 offset:6528
v_fma_f32 v62, v86, s52, v62
v_mfma_f32_16x16x32_bf16 v[168:171], a[200:203], v[36:39], v[168:171]
s_waitcnt lgkmcnt(4)
v_fma_f32 v63, v87, s52, v63
v_cvt_pk_bf16_f32 v244, v60, v61
v_mfma_f32_16x16x32_bf16 v[220:223], a[240:243], a[216:219], 0
ds_write_b128 v217, v[164:167] offset:1104
v_mfma_f32_16x16x32_bf16 v[224:227], a[240:243], a[220:223], 0
ds_read_b128 v[96:99], v9 offset:23552
v_cvt_pk_bf16_f32 v245, v62, v63
v_mfma_f32_16x16x32_bf16 v[172:175], a[204:207], v[36:39], v[148:151]
ds_write_b128 v217, v[168:171] offset:2208
v_mfma_f32_16x16x32_bf16 v[172:175], a[180:183], v[32:35], v[172:175]
ds_write_b64 v212, v[244:245] offset:6592
v_mfma_f32_16x16x32_bf16 v[172:175], a[156:159], v[28:31], v[172:175]
ds_read_b128 a[232:235], v1 offset:6656
s_waitcnt lgkmcnt(5)
v_mfma_f32_16x16x32_bf16 v[228:231], a[240:243], a[224:227], 0
ds_read_b128 a[236:239], v2 offset:6656
v_cvt_pk_bf16_f32 v40, v220, v221
v_mfma_f32_16x16x32_bf16 v[232:235], a[240:243], a[228:231], 0
v_add_f32 v64, v196, v64
v_add_f32 v65, v197, v65
v_mfma_f32_16x16x32_bf16 v[176:179], a[160:163], v[28:31], v[152:155]
ds_write_b128 v217, v[172:175] offset:3312
v_mfma_f32_16x16x32_bf16 v[176:179], a[184:187], v[32:35], v[176:179]
v_add_f32 v66, v198, v66
v_add_f32 v67, v199, v67
v_mfma_f32_16x16x32_bf16 v[176:179], a[208:211], v[36:39], v[176:179]
s_waitcnt lgkmcnt(1)
v_fma_f32 v64, v88, s52, v64
v_fma_f32 v65, v89, s52, v65
v_mfma_f32_16x16x32_bf16 v[236:239], a[240:243], a[232:235], 0
v_fma_f32 v66, v90, s52, v66
v_fma_f32 v67, v91, s52, v67
v_mfma_f32_16x16x32_bf16 v[240:243], a[240:243], a[236:239], 0
v_cvt_pk_bf16_f32 v246, v64, v65
v_cvt_pk_bf16_f32 v247, v66, v67
v_mfma_f32_16x16x32_bf16 v[180:183], a[212:215], v[36:39], v[156:159]
ds_write_b128 v217, v[176:179] offset:4416
v_mfma_f32_16x16x32_bf16 v[180:183], a[188:191], v[32:35], v[180:183]
ds_write_b64 v212, v[246:247] offset:6624
v_mfma_f32_16x16x32_bf16 v[180:183], a[164:167], v[28:31], v[180:183]
v_add_f32 v68, v200, v68
v_add_f32 v69, v201, v69
v_mfma_f32_16x16x32_bf16 v[136:139], a[72:75], v[28:31], v[112:115]
v_add_f32 v70, v202, v70
v_add_f32 v71, v203, v71
v_mfma_f32_16x16x32_bf16 v[136:139], a[96:99], v[32:35], v[136:139]
v_fma_f32 v68, v92, s52, v68
v_fma_f32 v69, v93, s52, v69
v_mfma_f32_16x16x32_bf16 v[136:139], a[120:123], v[36:39], v[136:139]
ds_write_b128 v217, v[180:183] offset:5520
v_mfma_f32_16x16x32_bf16 v[140:143], a[124:127], v[36:39], v[116:119]
v_fma_f32 v70, v94, s52, v70
v_fma_f32 v71, v95, s52, v71
v_mfma_f32_16x16x32_bf16 v[140:143], a[100:103], v[32:35], v[140:143]
v_cvt_pk_bf16_f32 v244, v68, v69
v_cvt_pk_bf16_f32 v245, v70, v71
v_mfma_f32_16x16x32_bf16 v[140:143], a[76:79], v[28:31], v[140:143]
ds_write_b64 v212, v[244:245] offset:6656
v_mfma_f32_16x16x32_bf16 v[144:147], a[80:83], v[28:31], v[120:123]
v_add_f32 v72, v204, v72
v_add_f32 v73, v205, v73
v_mfma_f32_16x16x32_bf16 v[144:147], a[104:107], v[32:35], v[144:147]
v_add_f32 v74, v206, v74
v_add_f32 v75, v207, v75
v_mfma_f32_16x16x32_bf16 v[144:147], a[128:131], v[36:39], v[144:147]
v_fma_f32 v72, v96, s52, v72
v_fma_f32 v73, v97, s52, v73
v_mfma_f32_16x16x32_bf16 v[148:151], a[132:135], v[36:39], v[124:127]
s_mov_b32 s56, s57
v_fma_f32 v74, v98, s52, v74
v_fma_f32 v75, v99, s52, v75
v_mfma_f32_16x16x32_bf16 v[148:151], a[108:111], v[32:35], v[148:151]
s_add_u32 s53, s53, s48
v_cvt_pk_bf16_f32 v246, v72, v73
v_cvt_pk_bf16_f32 v247, v74, v75
v_mfma_f32_16x16x32_bf16 v[148:151], a[84:87], v[28:31], v[148:151]
ds_write_b64 v212, v[246:247] offset:6688
v_mfma_f32_16x16x32_bf16 v[152:155], a[88:91], v[28:31], v[128:131]
s_waitcnt lgkmcnt(0)
s_barrier
v_cvt_pk_bf16_f32 v41, v222, v223
v_cvt_pk_bf16_f32 v42, v224, v225
v_mfma_f32_16x16x32_bf16 v[152:155], a[112:115], v[32:35], v[152:155]
s_sub_u32 s54, s54, 1
v_cvt_pk_bf16_f32 v43, v226, v227
v_cvt_pk_bf16_f32 v44, v228, v229
v_mfma_f32_16x16x32_bf16 v[152:155], a[136:139], v[36:39], v[152:155]
ds_read_b128 v[100:103], v213 offset:6528
v_cvt_pk_bf16_f32 v45, v230, v231
v_mfma_f32_16x16x32_bf16 v[156:159], a[140:143], v[36:39], v[132:135]
ds_read_b128 v[104:107], v214 offset:6528
v_cvt_pk_bf16_f32 v46, v232, v233
v_mfma_f32_16x16x32_bf16 v[156:159], a[116:119], v[32:35], v[156:159]
ds_read_b128 v[108:111], v215 offset:6528
v_cvt_pk_bf16_f32 v47, v234, v235
v_mfma_f32_16x16x32_bf16 v[156:159], a[92:95], v[28:31], v[156:159]
s_cselect_b32 s32, -28305408, 0
v_cvt_pk_bf16_f32 v48, v236, v237
v_cvt_pk_bf16_f32 v49, v238, v239
v_mfma_f32_16x16x32_bf16 v[184:187], a[144:147], v[40:43], v[136:139]
s_add_u32 s53, s53, s32
v_cvt_pk_bf16_f32 v50, v240, v241
v_cvt_pk_bf16_f32 v51, v242, v243
v_mfma_f32_16x16x32_bf16 v[184:187], a[168:171], v[44:47], v[184:187]
s_mov_b32 s57, s53
v_mfma_f32_16x16x32_bf16 v[184:187], a[192:195], v[48:51], v[184:187]
s_waitcnt lgkmcnt(2)
v_mfma_f32_16x16x32_bf16 v[188:191], a[196:199], v[48:51], v[140:143]
buffer_store_dwordx4 v[100:103], v10, s[20:23], s56 offen offset:0 sc1
v_mfma_f32_16x16x32_bf16 v[188:191], a[172:175], v[44:47], v[188:191]
v_mfma_f32_16x16x32_bf16 v[188:191], a[148:151], v[40:43], v[188:191]
ds_write_b128 v217, v[184:187] offset:26624
v_mfma_f32_16x16x32_bf16 v[192:195], a[152:155], v[40:43], v[144:147]
s_waitcnt lgkmcnt(2)
v_mfma_f32_16x16x32_bf16 v[192:195], a[176:179], v[44:47], v[192:195]
buffer_store_dwordx4 v[104:107], v10, s[20:23], s56 offen offset:1024 sc1
v_mfma_f32_16x16x32_bf16 v[192:195], a[200:203], v[48:51], v[192:195]
ds_write_b128 v217, v[188:191] offset:27728
v_mfma_f32_16x16x32_bf16 v[196:199], a[204:207], v[48:51], v[148:151]
s_waitcnt lgkmcnt(2)
v_mfma_f32_16x16x32_bf16 v[196:199], a[180:183], v[44:47], v[196:199]
buffer_store_dwordx4 v[108:111], v10, s[20:23], s56 offen offset:2048 sc1
v_mfma_f32_16x16x32_bf16 v[196:199], a[156:159], v[40:43], v[196:199]
ds_write_b128 v217, v[192:195] offset:28832
v_mfma_f32_16x16x32_bf16 v[200:203], a[160:163], v[40:43], v[152:155]
s_add_u32 s53, s53, s48
s_sub_u32 s54, s54, 1
s_cselect_b32 s32, -28305408, 0
v_mfma_f32_16x16x32_bf16 v[200:203], a[184:187], v[44:47], v[200:203]
s_add_u32 s56, s53, s32
v_mfma_f32_16x16x32_bf16 v[200:203], a[208:211], v[48:51], v[200:203]
ds_write_b128 v217, v[196:199] offset:29936
v_mfma_f32_16x16x32_bf16 v[204:207], a[212:215], v[48:51], v[156:159]
v_mfma_f32_16x16x32_bf16 v[204:207], a[188:191], v[44:47], v[204:207]
v_mfma_f32_16x16x32_bf16 v[204:207], a[164:167], v[40:43], v[204:207]
ds_write_b128 v217, v[200:203] offset:31040
s_nop 0
s_nop 0
s_nop 0
s_nop 0
s_nop 0
s_nop 0
s_nop 0
s_nop 0
ds_write_b128 v217, v[204:207] offset:32144
s_waitcnt lgkmcnt(0)
s_barrier
ds_read_b128 v[52:55], v248 offset:52992
ds_read_b128 v[56:59], v248 offset:53264
ds_read_b128 v[60:63], v25 offset:39680
ds_read_b128 v[64:67], v25 offset:39952
ds_read_b128 v[68:71], v25 offset:46336
ds_read_b128 v[72:75], v25 offset:46608
ds_read_b128 v[76:79], v249 offset:52992
ds_read_b128 v[80:83], v249 offset:53264
ds_read_b128 v[84:87], v26 offset:39680
ds_read_b128 v[88:91], v26 offset:39952
ds_read_b128 v[92:95], v26 offset:46336
ds_read_b128 v[96:99], v26 offset:46608
ds_read_b128 v[112:115], v250 offset:52992
ds_read_b128 v[116:119], v250 offset:53264
ds_read_b128 v[120:123], v27 offset:39680
ds_read_b128 v[124:127], v27 offset:39952
ds_read_b128 v[128:131], v27 offset:46336
ds_read_b128 v[132:135], v27 offset:46608
s_waitcnt lgkmcnt(14)
v_pk_add_f32 v[52:53], v[52:53], v[60:61]
v_pk_add_f32 v[54:55], v[54:55], v[62:63]
v_pk_add_f32 v[56:57], v[56:57], v[64:65]
v_pk_add_f32 v[58:59], v[58:59], v[66:67]
s_waitcnt lgkmcnt(12)
v_pk_fma_f32 v[52:53], v[68:69], v[252:253], v[52:53] op_sel_hi:[1,0,1]
v_pk_fma_f32 v[54:55], v[70:71], v[252:253], v[54:55] op_sel_hi:[1,0,1]
v_pk_fma_f32 v[56:57], v[72:73], v[252:253], v[56:57] op_sel_hi:[1,0,1]
v_pk_fma_f32 v[58:59], v[74:75], v[252:253], v[58:59] op_sel_hi:[1,0,1]
v_cvt_pk_bf16_f32 v60, v52, v53
v_cvt_pk_bf16_f32 v61, v54, v55
v_cvt_pk_bf16_f32 v62, v56, v57
v_cvt_pk_bf16_f32 v63, v58, v59
buffer_store_dwordx4 v[60:63], v10, s[20:23], s56 offen offset:0 sc1
s_waitcnt lgkmcnt(8)
v_pk_add_f32 v[76:77], v[76:77], v[84:85]
v_pk_add_f32 v[78:79], v[78:79], v[86:87]
v_pk_add_f32 v[80:81], v[80:81], v[88:89]
v_pk_add_f32 v[82:83], v[82:83], v[90:91]
s_waitcnt lgkmcnt(6)
v_pk_fma_f32 v[76:77], v[92:93], v[254:255], v[76:77] op_sel_hi:[1,0,1]
v_pk_fma_f32 v[78:79], v[94:95], v[254:255], v[78:79] op_sel_hi:[1,0,1]
v_pk_fma_f32 v[80:81], v[96:97], v[254:255], v[80:81] op_sel_hi:[1,0,1]
v_pk_fma_f32 v[82:83], v[98:99], v[254:255], v[82:83] op_sel_hi:[1,0,1]
v_cvt_pk_bf16_f32 v84, v76, v77
v_cvt_pk_bf16_f32 v85, v78, v79
v_cvt_pk_bf16_f32 v86, v80, v81
v_cvt_pk_bf16_f32 v87, v82, v83
buffer_store_dwordx4 v[84:87], v10, s[20:23], s56 offen offset:1024 sc1
s_waitcnt lgkmcnt(2)
v_pk_add_f32 v[112:113], v[112:113], v[120:121]
v_pk_add_f32 v[114:115], v[114:115], v[122:123]
v_pk_add_f32 v[116:117], v[116:117], v[124:125]
v_pk_add_f32 v[118:119], v[118:119], v[126:127]
s_waitcnt lgkmcnt(0)
v_pk_fma_f32 v[112:113], v[128:129], v[218:219], v[112:113] op_sel_hi:[1,0,1]
v_pk_fma_f32 v[114:115], v[130:131], v[218:219], v[114:115] op_sel_hi:[1,0,1]
v_pk_fma_f32 v[116:117], v[132:133], v[218:219], v[116:117] op_sel_hi:[1,0,1]
v_pk_fma_f32 v[118:119], v[134:135], v[218:219], v[118:119] op_sel_hi:[1,0,1]
v_cvt_pk_bf16_f32 v120, v112, v113
v_cvt_pk_bf16_f32 v121, v114, v115
v_cvt_pk_bf16_f32 v122, v116, v117
v_cvt_pk_bf16_f32 v123, v118, v119
buffer_store_dwordx4 v[120:123], v10, s[20:23], s56 offen offset:2048 sc1
s_endpgm
.fill 304, 4, 0xbf800000
Lprod:
s_add_u32 s39, s10, 4
s_mul_i32 s33, s39, 6528
s_add_u32 s40, s40, s33
s_add_u32 s37, s34, s39
s_sub_u32 s37, s37, 1
s_cmp_ge_u32 s37, 384
s_cselect_b32 s33, 384, 0
s_addc_u32 s38, s35, 0
s_sub_u32 s37, s37, s33
s_mul_i32 s36, s37, 73728
s_mul_i32 s33, s38, 6144
s_add_u32 s36, s36, s33
s_mov_b32 s20, s8
s_mov_b32 s21, s9
s_mov_b32 s22, 28311552
s_mov_b32 s23, 0x20000
s_cmp_eq_u32 s29, 0
s_cselect_b32 s52, 1.0, -1.0
s_mov_b32 s100, s52
s_mov_b32 s101, s52
s_add_u32 s56, s34, 16
s_mul_i32 s56, s56, 73728
s_mul_i32 s33, s35, 6144
s_add_u32 s56, s56, s33
s_cmp_le_u32 s31, 16
s_cselect_b32 s33, -28305408, 0
s_add_u32 s56, s56, s33
v_and_b32 v48, 15, v0
v_lshrrev_b32 v49, 4, v0
v_and_b32 v50, 1, v48
v_lshlrev_b32 v50, 4, v50
v_mov_b32 v51, 0xffff
v_lshlrev_b32 v51, v50, v51
v_and_b32 v50, 1, v49
v_lshlrev_b32 v50, 3, v50
v_xor_b32 v50, v50, v48
v_lshrrev_b32 v50, 1, v50
v_cmp_eq_u32 vcc, 0, v50
s_nop 1
v_cndmask_b32 v52, 0, v51, vcc
v_cmp_eq_u32 vcc, 1, v50
s_nop 1
v_cndmask_b32 v53, 0, v51, vcc
v_cmp_eq_u32 vcc, 2, v50
s_nop 1
v_cndmask_b32 v54, 0, v51, vcc
v_cmp_eq_u32 vcc, 3, v50
s_nop 1
v_cndmask_b32 v55, 0, v51, vcc
s_lshl_b32 s3, s29, 15
s_lshl_b32 s32, s29, 31
s_or_b32 s3, s3, s32
s_or_b32 s6, s3, 0x3f803f80
s_or_b32 s7, s3, 0x3f003f00
v_mov_b32 v50, 0x3f003f00
v_mov_b32 v51, 0x3f003f00
v_cmp_lt_u32 vcc, 1, v49
s_nop 1
v_cndmask_b32 v50, v50, v51, vcc
v_and_b32 v51, v50, v52
v_accvgpr_write_b32 a172, v51
v_and_b32 v51, v50, v53
v_accvgpr_write_b32 a173, v51
v_and_b32 v51, v50, v54
v_accvgpr_write_b32 a174, v51
v_and_b32 v51, v50, v55
v_accvgpr_write_b32 a175, v51
v_mov_b32 v50, s7
v_mov_b32 v51, 0
v_cmp_lt_u32 vcc, 1, v49
s_nop 1
v_cndmask_b32 v50, v50, v51, vcc
v_and_b32 v51, v50, v52
v_accvgpr_write_b32 a176, v51
v_and_b32 v51, v50, v53
v_accvgpr_write_b32 a177, v51
v_and_b32 v51, v50, v54
v_accvgpr_write_b32 a178, v51
v_and_b32 v51, v50, v55
v_accvgpr_write_b32 a179, v51
v_mov_b32 v50, 0
v_mov_b32 v51, s7
v_cmp_lt_u32 vcc, 1, v49
s_nop 1
v_cndmask_b32 v50, v50, v51, vcc
v_and_b32 v51, v50, v52
v_accvgpr_write_b32 a180, v51
v_and_b32 v51, v50, v53
v_accvgpr_write_b32 a181, v51
v_and_b32 v51, v50, v54
v_accvgpr_write_b32 a182, v51
v_and_b32 v51, v50, v55
v_accvgpr_write_b32 a183, v51
v_mov_b32 v50, 0x3f803f80
v_mov_b32 v51, s6
v_cmp_lt_u32 vcc, 1, v49
s_nop 1
v_cndmask_b32 v50, v50, v51, vcc
v_and_b32 v51, v50, v52
v_accvgpr_write_b32 a168, v51
v_and_b32 v51, v50, v53
v_accvgpr_write_b32 a169, v51
v_and_b32 v51, v50, v54
v_accvgpr_write_b32 a170, v51
v_and_b32 v51, v50, v55
v_accvgpr_write_b32 a171, v51
v_mul_u32_u24 v10, 192, v48
v_and_b32 v50, 1, v49
v_lshl_add_u32 v9, v50, 4, v10
v_lshrrev_b32 v50, 1, v49
v_mul_u32_u24 v50, 12288, v50
v_add_u32 v9, v50, v9
v_lshrrev_b32 v50, 1, v48
v_and_b32 v50, 2, v50
v_xor_b32 v51, v50, v49
v_lshlrev_b32 v50, 4, v50
v_sub_u32 v14, v9, v50
v_add_u32 v14, 108544, v14
v_add_u32 v9, v9, v50
v_add_u32 v9, 108544, v9
v_lshl_add_u32 v10, v51, 4, v10
v_add_u32 v10, 114688, v10
s_add_u32 s3, s29, 1
s_sub_u32 s6, 2, s29
v_mov_b32 v50, s3
v_mov_b32 v51, s6
v_cmp_lt_u32 vcc, 1, v49
s_nop 1
v_cndmask_b32 v50, v50, v51, vcc
v_lshrrev_b32 v51, 1, v50
v_add_u32 v51, v51, v48
v_and_b32 v50, 1, v50
v_mul_u32_u24 v50, 12, v50
v_and_b32 v4, 1, v49
v_add_u32 v50, v50, v4
v_and_b32 v4, 6, v51
v_mul_u32_u24 v51, 24, v51
v_add_u32 v1, 0, v50
v_xor_b32 v1, v4, v1
v_add_lshl_u32 v1, v1, v51, 4
v_add_u32 v2, 2, v50
v_xor_b32 v2, v4, v2
v_add_lshl_u32 v2, v2, v51, 4
v_add_u32 v3, 4, v50
v_xor_b32 v3, v4, v3
v_add_lshl_u32 v3, v3, v51, 4
v_add_u32 v50, 6, v50
v_xor_b32 v4, v50, v4
v_add_lshl_u32 v4, v4, v51, 4
s_mul_i32 s3, s29, 6144
s_add_u32 s3, s3, 139264
v_lshlrev_b32 v11, 4, v0
v_add_u32 v11, s3, v11
v_lshrrev_b32 v50, 4, v0
v_add_lshl_u32 v15, v50, v0, 4
s_mul_i32 s3, s29, 6656
s_add_u32 s3, s3, 13056
v_add_u32 v15, s3, v15
s_mov_b64 vcc, 0
s_waitcnt vmcnt(0)
s_barrier
ds_read_b128 a[184:187], v9 offset:0
ds_read_b128 a[188:191], v14 offset:32
ds_read_b128 a[192:195], v10 offset:0
ds_read_b128 a[196:199], v9 offset:64
ds_read_b128 a[200:203], v14 offset:96
ds_read_b128 a[204:207], v10 offset:64
ds_read_b128 a[208:211], v9 offset:128
ds_read_b128 a[212:215], v14 offset:160
ds_read_b128 a[216:219], v10 offset:128
s_waitcnt lgkmcnt(6)
v_mfma_f32_16x16x32_bf16 v[48:51], a[184:187], a[172:175], 0
ds_read_b128 a[220:223], v9 offset:3072
v_mfma_f32_16x16x32_bf16 v[48:51], a[192:195], a[176:179], v[48:51]
ds_read_b128 a[224:227], v14 offset:3104
v_mfma_f32_16x16x32_bf16 v[52:55], a[192:195], a[180:183], 0
ds_read_b128 a[228:231], v10 offset:3072
v_mfma_f32_16x16x32_bf16 v[52:55], a[188:191], a[172:175], v[52:55]
ds_read_b128 a[232:235], v9 offset:3136
s_waitcnt lgkmcnt(7)
v_mfma_f32_16x16x32_bf16 v[56:59], a[196:199], a[172:175], 0
ds_read_b128 a[236:239], v14 offset:3168
v_cvt_pk_bf16_f32 v24, v48, v49
v_mfma_f32_16x16x32_bf16 v[56:59], a[204:207], a[176:179], v[56:59]
ds_read_b128 a[240:243], v10 offset:3136
v_cvt_pk_bf16_f32 v25, v50, v51
v_mfma_f32_16x16x32_bf16 v[60:63], a[204:207], a[180:183], 0
ds_read_b128 a[184:187], v9 offset:3200
v_accvgpr_write_b32 a0, v24
v_mfma_f32_16x16x32_bf16 v[60:63], a[200:203], a[172:175], v[60:63]
s_waitcnt lgkmcnt(7)
v_accvgpr_write_b32 a1, v25
v_cvt_pk_bf16_f32 v26, v52, v53
v_mfma_f32_16x16x32_bf16 v[64:67], a[208:211], a[172:175], 0
ds_read_b128 a[188:191], v14 offset:3232
v_cvt_pk_bf16_f32 v27, v54, v55
v_mfma_f32_16x16x32_bf16 v[64:67], a[216:219], a[176:179], v[64:67]
ds_read_b128 a[192:195], v10 offset:3200
v_accvgpr_write_b32 a4, v26
v_mfma_f32_16x16x32_bf16 v[48:51], a[216:219], a[180:183], 0
v_accvgpr_write_b32 a5, v27
v_cvt_pk_bf16_f32 v24, v56, v57
v_mfma_f32_16x16x32_bf16 v[48:51], a[212:215], a[172:175], v[48:51]
s_barrier
s_waitcnt lgkmcnt(6)
v_mfma_f32_16x16x32_bf16 v[52:55], a[220:223], a[172:175], 0
ds_read_b128 a[196:199], v9 offset:18432
v_cvt_pk_bf16_f32 v25, v58, v59
v_mfma_f32_16x16x32_bf16 v[52:55], a[228:231], a[176:179], v[52:55]
ds_read_b128 a[200:203], v14 offset:18464
v_accvgpr_write_b32 a8, v24
v_accvgpr_write_b32 a9, v25
v_mfma_f32_16x16x32_bf16 v[56:59], a[228:231], a[180:183], 0
ds_read_b128 a[204:207], v10 offset:18432
v_cvt_pk_bf16_f32 v26, v60, v61
v_cvt_pk_bf16_f32 v27, v62, v63
v_mfma_f32_16x16x32_bf16 v[56:59], a[224:227], a[172:175], v[56:59]
s_waitcnt lgkmcnt(6)
v_accvgpr_write_b32 a12, v26
v_accvgpr_write_b32 a13, v27
v_mfma_f32_16x16x32_bf16 v[60:63], a[232:235], a[172:175], 0
ds_read_b128 a[208:211], v9 offset:18496
v_cvt_pk_bf16_f32 v24, v64, v65
v_cvt_pk_bf16_f32 v25, v66, v67
v_mfma_f32_16x16x32_bf16 v[60:63], a[240:243], a[176:179], v[60:63]
ds_read_b128 a[212:215], v14 offset:18528
v_accvgpr_write_b32 a16, v24
v_accvgpr_write_b32 a17, v25
v_mfma_f32_16x16x32_bf16 v[64:67], a[240:243], a[180:183], 0
ds_read_b128 a[216:219], v10 offset:18496
v_cvt_pk_bf16_f32 v16, v48, v49
v_mfma_f32_16x16x32_bf16 v[64:67], a[236:239], a[172:175], v[64:67]
ds_read_b128 a[220:223], v9 offset:18560
v_cvt_pk_bf16_f32 v17, v50, v51
s_waitcnt lgkmcnt(7)
v_mfma_f32_16x16x32_bf16 v[48:51], a[184:187], a[172:175], 0
ds_read_b128 a[224:227], v14 offset:18592
v_cvt_pk_bf16_f32 v24, v52, v53
v_cvt_pk_bf16_f32 v25, v54, v55
v_mfma_f32_16x16x32_bf16 v[48:51], a[192:195], a[176:179], v[48:51]
ds_read_b128 a[228:231], v10 offset:18560
v_accvgpr_write_b32 a2, v24
v_accvgpr_write_b32 a3, v25
v_mfma_f32_16x16x32_bf16 v[52:55], a[192:195], a[180:183], 0
ds_read_b128 a[232:235], v9 offset:21504
v_cvt_pk_bf16_f32 v26, v56, v57
v_cvt_pk_bf16_f32 v27, v58, v59
v_mfma_f32_16x16x32_bf16 v[52:55], a[188:191], a[172:175], v[52:55]
s_waitcnt lgkmcnt(7)
v_accvgpr_write_b32 a6, v26
v_accvgpr_write_b32 a7, v27
v_mfma_f32_16x16x32_bf16 v[56:59], a[196:199], a[172:175], 0
ds_read_b128 a[236:239], v14 offset:21536
v_cvt_pk_bf16_f32 v24, v60, v61
v_cvt_pk_bf16_f32 v25, v62, v63
v_mfma_f32_16x16x32_bf16 v[56:59], a[204:207], a[176:179], v[56:59]
ds_read_b128 a[240:243], v10 offset:21504
v_accvgpr_write_b32 a10, v24
v_accvgpr_write_b32 a11, v25
v_mfma_f32_16x16x32_bf16 v[60:63], a[204:207], a[180:183], 0
ds_read_b128 a[184:187], v9 offset:21568
v_cvt_pk_bf16_f32 v26, v64, v65
v_cvt_pk_bf16_f32 v27, v66, v67
v_mfma_f32_16x16x32_bf16 v[60:63], a[200:203], a[172:175], v[60:63]
s_waitcnt lgkmcnt(7)
v_accvgpr_write_b32 a14, v26
v_accvgpr_write_b32 a15, v27
v_mfma_f32_16x16x32_bf16 v[64:67], a[208:211], a[172:175], 0
ds_read_b128 a[188:191], v14 offset:21600
v_cvt_pk_bf16_f32 v24, v48, v49
v_cvt_pk_bf16_f32 v25, v50, v51
v_mfma_f32_16x16x32_bf16 v[64:67], a[216:219], a[176:179], v[64:67]
ds_read_b128 a[192:195], v10 offset:21568
v_accvgpr_write_b32 a18, v24
v_accvgpr_write_b32 a19, v25
v_mfma_f32_16x16x32_bf16 v[48:51], a[216:219], a[180:183], 0
ds_read_b128 a[196:199], v9 offset:21632
v_cvt_pk_bf16_f32 v18, v52, v53
v_mfma_f32_16x16x32_bf16 v[48:51], a[212:215], a[172:175], v[48:51]
ds_read_b128 a[200:203], v14 offset:21664
v_cvt_pk_bf16_f32 v19, v54, v55
s_waitcnt lgkmcnt(8)
v_mfma_f32_16x16x32_bf16 v[52:55], a[220:223], a[172:175], 0
ds_read_b128 a[204:207], v10 offset:21632
v_cvt_pk_bf16_f32 v20, v56, v57
v_mfma_f32_16x16x32_bf16 v[52:55], a[228:231], a[176:179], v[52:55]
v_cvt_pk_bf16_f32 v21, v58, v59
v_cvt_pk_bf16_f32 v68, v60, v61
v_mfma_f32_16x16x32_bf16 v[56:59], a[228:231], a[180:183], 0
v_cvt_pk_bf16_f32 v69, v62, v63
v_cvt_pk_bf16_f32 v72, v64, v65
v_mfma_f32_16x16x32_bf16 v[56:59], a[224:227], a[172:175], v[56:59]
s_barrier
s_waitcnt lgkmcnt(6)
v_mfma_f32_16x16x32_bf16 v[60:63], a[232:235], a[172:175], 0
ds_read_b128 a[208:211], v9 offset:36864
v_cvt_pk_bf16_f32 v73, v66, v67
v_mfma_f32_16x16x32_bf16 v[60:63], a[240:243], a[176:179], v[60:63]
ds_read_b128 a[212:215], v14 offset:36896
v_cvt_pk_bf16_f32 v76, v48, v49
v_mfma_f32_16x16x32_bf16 v[64:67], a[240:243], a[180:183], 0
ds_read_b128 a[216:219], v10 offset:36864
v_cvt_pk_bf16_f32 v77, v50, v51
v_mfma_f32_16x16x32_bf16 v[64:67], a[236:239], a[172:175], v[64:67]
s_waitcnt lgkmcnt(6)
v_cvt_pk_bf16_f32 v80, v52, v53
v_cvt_pk_bf16_f32 v81, v54, v55
v_mfma_f32_16x16x32_bf16 v[48:51], a[184:187], a[172:175], 0
ds_read_b128 a[220:223], v9 offset:36928
v_cvt_pk_bf16_f32 v84, v56, v57
v_mfma_f32_16x16x32_bf16 v[48:51], a[192:195], a[176:179], v[48:51]
ds_read_b128 a[224:227], v14 offset:36960
v_cvt_pk_bf16_f32 v85, v58, v59
v_mfma_f32_16x16x32_bf16 v[52:55], a[192:195], a[180:183], 0
ds_read_b128 a[228:231], v10 offset:36928
v_cvt_pk_bf16_f32 v22, v60, v61
v_mfma_f32_16x16x32_bf16 v[52:55], a[188:191], a[172:175], v[52:55]
s_waitcnt lgkmcnt(6)
v_cvt_pk_bf16_f32 v23, v62, v63
v_cvt_pk_bf16_f32 v70, v64, v65
v_mfma_f32_16x16x32_bf16 v[56:59], a[196:199], a[172:175], 0
ds_read_b128 a[232:235], v9 offset:36992
v_cvt_pk_bf16_f32 v71, v66, v67
v_mfma_f32_16x16x32_bf16 v[56:59], a[204:207], a[176:179], v[56:59]
ds_read_b128 a[236:239], v14 offset:37024
v_cvt_pk_bf16_f32 v74, v48, v49
v_mfma_f32_16x16x32_bf16 v[60:63], a[204:207], a[180:183], 0
ds_read_b128 a[240:243], v10 offset:36992
v_cvt_pk_bf16_f32 v75, v50, v51
v_mfma_f32_16x16x32_bf16 v[60:63], a[200:203], a[172:175], v[60:63]
s_waitcnt lgkmcnt(6)
v_cvt_pk_bf16_f32 v78, v52, v53
v_cvt_pk_bf16_f32 v79, v54, v55
v_mfma_f32_16x16x32_bf16 v[64:67], a[208:211], a[172:175], 0
ds_read_b128 a[184:187], v9 offset:39936
v_cvt_pk_bf16_f32 v82, v56, v57
v_mfma_f32_16x16x32_bf16 v[64:67], a[216:219], a[176:179], v[64:67]
ds_read_b128 a[188:191], v14 offset:39968
v_cvt_pk_bf16_f32 v83, v58, v59
v_mfma_f32_16x16x32_bf16 v[48:51], a[216:219], a[180:183], 0
ds_read_b128 a[192:195], v10 offset:39936
v_cvt_pk_bf16_f32 v86, v60, v61
v_mfma_f32_16x16x32_bf16 v[48:51], a[212:215], a[172:175], v[48:51]
ds_read_b128 a[196:199], v9 offset:40000
s_waitcnt lgkmcnt(7)
v_mfma_f32_16x16x32_bf16 v[52:55], a[220:223], a[172:175], 0
ds_read_b128 a[200:203], v14 offset:40032
v_cvt_pk_bf16_f32 v87, v62, v63
v_mfma_f32_16x16x32_bf16 v[52:55], a[228:231], a[176:179], v[52:55]
ds_read_b128 a[204:207], v10 offset:40000
v_cvt_pk_bf16_f32 v88, v64, v65
v_mfma_f32_16x16x32_bf16 v[56:59], a[228:231], a[180:183], 0
ds_read_b128 a[208:211], v9 offset:40064
v_cvt_pk_bf16_f32 v89, v66, v67
v_mfma_f32_16x16x32_bf16 v[56:59], a[224:227], a[172:175], v[56:59]
ds_read_b128 a[212:215], v14 offset:40096
s_waitcnt lgkmcnt(8)
v_mfma_f32_16x16x32_bf16 v[60:63], a[232:235], a[172:175], 0
ds_read_b128 a[216:219], v10 offset:40064
v_cvt_pk_bf16_f32 v92, v48, v49
v_mfma_f32_16x16x32_bf16 v[60:63], a[240:243], a[176:179], v[60:63]
v_cvt_pk_bf16_f32 v93, v50, v51
v_add_u32 v9, -55296, v9
v_mfma_f32_16x16x32_bf16 v[64:67], a[240:243], a[180:183], 0
v_add_u32 v10, -55296, v10
v_cvt_pk_bf16_f32 v96, v52, v53
v_mfma_f32_16x16x32_bf16 v[64:67], a[236:239], a[172:175], v[64:67]
s_waitcnt lgkmcnt(6)
v_add_u32 v14, -55296, v14
v_cvt_pk_bf16_f32 v97, v54, v55
v_mfma_f32_16x16x32_bf16 v[48:51], a[184:187], a[172:175], 0
s_waitcnt lgkmcnt(0)
s_barrier
v_cvt_pk_bf16_f32 v100, v56, v57
v_mfma_f32_16x16x32_bf16 v[48:51], a[192:195], a[176:179], v[48:51]
ds_read_b128 a[220:223], v9 offset:0
v_cvt_pk_bf16_f32 v101, v58, v59
v_mfma_f32_16x16x32_bf16 v[52:55], a[192:195], a[180:183], 0
ds_read_b128 a[224:227], v14 offset:32
v_cvt_pk_bf16_f32 v104, v60, v61
v_mfma_f32_16x16x32_bf16 v[52:55], a[188:191], a[172:175], v[52:55]
ds_read_b128 a[228:231], v10 offset:0
v_cvt_pk_bf16_f32 v105, v62, v63
v_mfma_f32_16x16x32_bf16 v[56:59], a[196:199], a[172:175], 0
ds_read_b128 a[232:235], v9 offset:64
v_cvt_pk_bf16_f32 v108, v64, v65
v_mfma_f32_16x16x32_bf16 v[56:59], a[204:207], a[176:179], v[56:59]
ds_read_b128 a[236:239], v14 offset:96
v_cvt_pk_bf16_f32 v109, v66, v67
v_mfma_f32_16x16x32_bf16 v[60:63], a[204:207], a[180:183], 0
ds_read_b128 a[240:243], v10 offset:64
v_cvt_pk_bf16_f32 v90, v48, v49
v_mfma_f32_16x16x32_bf16 v[60:63], a[200:203], a[172:175], v[60:63]
ds_read_b128 a[184:187], v9 offset:128
v_cvt_pk_bf16_f32 v91, v50, v51
v_mfma_f32_16x16x32_bf16 v[64:67], a[208:211], a[172:175], 0
ds_read_b128 a[188:191], v14 offset:160
v_cvt_pk_bf16_f32 v94, v52, v53
v_mfma_f32_16x16x32_bf16 v[64:67], a[216:219], a[176:179], v[64:67]
ds_read_b128 a[192:195], v10 offset:128
v_cvt_pk_bf16_f32 v95, v54, v55
v_mfma_f32_16x16x32_bf16 v[48:51], a[216:219], a[180:183], 0
ds_read_b128 a[196:199], v9 offset:3072
v_cvt_pk_bf16_f32 v98, v56, v57
v_mfma_f32_16x16x32_bf16 v[48:51], a[212:215], a[172:175], v[48:51]
s_waitcnt lgkmcnt(7)
v_cvt_pk_bf16_f32 v99, v58, v59
v_cvt_pk_bf16_f32 v102, v60, v61
v_mfma_f32_16x16x32_bf16 v[52:55], a[220:223], a[172:175], 0
ds_read_b128 a[200:203], v14 offset:3104
v_cvt_pk_bf16_f32 v103, v62, v63
v_mfma_f32_16x16x32_bf16 v[52:55], a[228:231], a[176:179], v[52:55]
ds_read_b128 a[204:207], v10 offset:3072
v_cvt_pk_bf16_f32 v106, v64, v65
v_mfma_f32_16x16x32_bf16 v[56:59], a[228:231], a[180:183], 0
ds_read_b128 a[208:211], v9 offset:3136
v_cvt_pk_bf16_f32 v107, v66, v67
v_mfma_f32_16x16x32_bf16 v[56:59], a[224:227], a[172:175], v[56:59]
s_waitcnt lgkmcnt(7)
v_cvt_pk_bf16_f32 v110, v48, v49
v_cvt_pk_bf16_f32 v111, v50, v51
v_mfma_f32_16x16x32_bf16 v[60:63], a[232:235], a[172:175], 0
ds_read_b128 a[212:215], v14 offset:3168
v_cvt_pk_bf16_f32 v112, v52, v53
v_mfma_f32_16x16x32_bf16 v[60:63], a[240:243], a[176:179], v[60:63]
ds_read_b128 a[216:219], v10 offset:3136
v_cvt_pk_bf16_f32 v113, v54, v55
v_mfma_f32_16x16x32_bf16 v[64:67], a[240:243], a[180:183], 0
ds_read_b128 a[220:223], v9 offset:3200
v_cvt_pk_bf16_f32 v116, v56, v57
v_mfma_f32_16x16x32_bf16 v[64:67], a[236:239], a[172:175], v[64:67]
s_waitcnt lgkmcnt(7)
v_cvt_pk_bf16_f32 v117, v58, v59
v_cvt_pk_bf16_f32 v120, v60, v61
v_mfma_f32_16x16x32_bf16 v[48:51], a[184:187], a[172:175], 0
ds_read_b128 a[224:227], v14 offset:3232
v_cvt_pk_bf16_f32 v121, v62, v63
v_mfma_f32_16x16x32_bf16 v[48:51], a[192:195], a[176:179], v[48:51]
ds_read_b128 a[228:231], v10 offset:3200
v_cvt_pk_bf16_f32 v124, v64, v65
v_mfma_f32_16x16x32_bf16 v[52:55], a[192:195], a[180:183], 0
v_cvt_pk_bf16_f32 v125, v66, v67
v_mfma_f32_16x16x32_bf16 v[52:55], a[188:191], a[172:175], v[52:55]
s_barrier
s_waitcnt lgkmcnt(6)
v_mfma_f32_16x16x32_bf16 v[56:59], a[196:199], a[172:175], 0
ds_read_b128 a[232:235], v9 offset:18432
v_cvt_pk_bf16_f32 v128, v48, v49
v_mfma_f32_16x16x32_bf16 v[56:59], a[204:207], a[176:179], v[56:59]
ds_read_b128 a[236:239], v14 offset:18464
v_cvt_pk_bf16_f32 v129, v50, v51
v_mfma_f32_16x16x32_bf16 v[60:63], a[204:207], a[180:183], 0
ds_read_b128 a[240:243], v10 offset:18432
v_cvt_pk_bf16_f32 v132, v52, v53
v_mfma_f32_16x16x32_bf16 v[60:63], a[200:203], a[172:175], v[60:63]
ds_read_b128 a[184:187], v9 offset:18496
s_waitcnt lgkmcnt(7)
v_mfma_f32_16x16x32_bf16 v[64:67], a[208:211], a[172:175], 0
ds_read_b128 a[188:191], v14 offset:18528
v_cvt_pk_bf16_f32 v133, v54, v55
v_mfma_f32_16x16x32_bf16 v[64:67], a[216:219], a[176:179], v[64:67]
ds_read_b128 a[192:195], v10 offset:18496
v_cvt_pk_bf16_f32 v114, v56, v57
v_mfma_f32_16x16x32_bf16 v[48:51], a[216:219], a[180:183], 0
ds_read_b128 a[196:199], v9 offset:18560
v_cvt_pk_bf16_f32 v115, v58, v59
v_mfma_f32_16x16x32_bf16 v[48:51], a[212:215], a[172:175], v[48:51]
s_waitcnt lgkmcnt(7)
v_cvt_pk_bf16_f32 v118, v60, v61
v_cvt_pk_bf16_f32 v119, v62, v63
v_mfma_f32_16x16x32_bf16 v[52:55], a[220:223], a[172:175], 0
ds_read_b128 a[200:203], v14 offset:18592
v_cvt_pk_bf16_f32 v122, v64, v65
v_mfma_f32_16x16x32_bf16 v[52:55], a[228:231], a[176:179], v[52:55]
ds_read_b128 a[204:207], v10 offset:18560
v_cvt_pk_bf16_f32 v123, v66, v67
v_mfma_f32_16x16x32_bf16 v[56:59], a[228:231], a[180:183], 0
ds_read_b128 a[208:211], v9 offset:21504
v_cvt_pk_bf16_f32 v126, v48, v49
v_mfma_f32_16x16x32_bf16 v[56:59], a[224:227], a[172:175], v[56:59]
v_cvt_pk_bf16_f32 v127, v50, v51
v_cvt_pk_bf16_f32 v130, v52, v53
s_waitcnt lgkmcnt(7)
v_mfma_f32_16x16x32_bf16 v[60:63], a[232:235], a[172:175], 0
ds_read_b128 a[212:215], v14 offset:21536
v_cvt_pk_bf16_f32 v131, v54, v55
v_mfma_f32_16x16x32_bf16 v[60:63], a[240:243], a[176:179], v[60:63]
ds_read_b128 a[216:219], v10 offset:21504
v_cvt_pk_bf16_f32 v134, v56, v57
v_mfma_f32_16x16x32_bf16 v[64:67], a[240:243], a[180:183], 0
ds_read_b128 a[220:223], v9 offset:21568
v_cvt_pk_bf16_f32 v135, v58, v59
v_mfma_f32_16x16x32_bf16 v[64:67], a[236:239], a[172:175], v[64:67]
ds_read_b128 a[224:227], v14 offset:21600
s_waitcnt lgkmcnt(8)
v_mfma_f32_16x16x32_bf16 v[48:51], a[184:187], a[172:175], 0
ds_read_b128 a[228:231], v10 offset:21568
v_cvt_pk_bf16_f32 v136, v60, v61
v_mfma_f32_16x16x32_bf16 v[48:51], a[192:195], a[176:179], v[48:51]
ds_read_b128 a[232:235], v9 offset:21632
v_cvt_pk_bf16_f32 v137, v62, v63
v_mfma_f32_16x16x32_bf16 v[52:55], a[192:195], a[180:183], 0
ds_read_b128 a[236:239], v14 offset:21664
v_cvt_pk_bf16_f32 v140, v64, v65
v_mfma_f32_16x16x32_bf16 v[52:55], a[188:191], a[172:175], v[52:55]
s_waitcnt lgkmcnt(8)
v_cvt_pk_bf16_f32 v141, v66, v67
v_cvt_pk_bf16_f32 v144, v48, v49
v_mfma_f32_16x16x32_bf16 v[56:59], a[196:199], a[172:175], 0
ds_read_b128 a[240:243], v10 offset:21632
v_cvt_pk_bf16_f32 v145, v50, v51
v_mfma_f32_16x16x32_bf16 v[56:59], a[204:207], a[176:179], v[56:59]
v_mfma_f32_16x16x32_bf16 v[60:63], a[204:207], a[180:183], 0
v_cvt_pk_bf16_f32 v148, v52, v53
v_cvt_pk_bf16_f32 v149, v54, v55
v_mfma_f32_16x16x32_bf16 v[60:63], a[200:203], a[172:175], v[60:63]
s_barrier
s_waitcnt lgkmcnt(6)
v_mfma_f32_16x16x32_bf16 v[64:67], a[208:211], a[172:175], 0
ds_read_b128 a[184:187], v9 offset:36864
v_cvt_pk_bf16_f32 v152, v56, v57
v_mfma_f32_16x16x32_bf16 v[64:67], a[216:219], a[176:179], v[64:67]
ds_read_b128 a[188:191], v14 offset:36896
v_cvt_pk_bf16_f32 v153, v58, v59
v_mfma_f32_16x16x32_bf16 v[48:51], a[216:219], a[180:183], 0
ds_read_b128 a[192:195], v10 offset:36864
v_cvt_pk_bf16_f32 v156, v60, v61
v_mfma_f32_16x16x32_bf16 v[48:51], a[212:215], a[172:175], v[48:51]
ds_read_b128 a[196:199], v9 offset:36928
s_waitcnt lgkmcnt(7)
v_mfma_f32_16x16x32_bf16 v[52:55], a[220:223], a[172:175], 0
ds_read_b128 a[200:203], v14 offset:36960
v_cvt_pk_bf16_f32 v157, v62, v63
v_mfma_f32_16x16x32_bf16 v[52:55], a[228:231], a[176:179], v[52:55]
ds_read_b128 a[204:207], v10 offset:36928
v_cvt_pk_bf16_f32 v138, v64, v65
v_mfma_f32_16x16x32_bf16 v[56:59], a[228:231], a[180:183], 0
ds_read_b128 a[208:211], v9 offset:36992
v_cvt_pk_bf16_f32 v139, v66, v67
v_mfma_f32_16x16x32_bf16 v[56:59], a[224:227], a[172:175], v[56:59]
s_waitcnt lgkmcnt(7)
v_cvt_pk_bf16_f32 v142, v48, v49
v_cvt_pk_bf16_f32 v143, v50, v51
v_mfma_f32_16x16x32_bf16 v[60:63], a[232:235], a[172:175], 0
ds_read_b128 a[212:215], v14 offset:37024
v_cvt_pk_bf16_f32 v146, v52, v53
v_mfma_f32_16x16x32_bf16 v[60:63], a[240:243], a[176:179], v[60:63]
ds_read_b128 a[216:219], v10 offset:36992
v_cvt_pk_bf16_f32 v147, v54, v55
v_mfma_f32_16x16x32_bf16 v[64:67], a[240:243], a[180:183], 0
ds_read_b128 a[220:223], v9 offset:39936
v_cvt_pk_bf16_f32 v150, v56, v57
v_mfma_f32_16x16x32_bf16 v[64:67], a[236:239], a[172:175], v[64:67]
s_waitcnt lgkmcnt(7)
v_cvt_pk_bf16_f32 v151, v58, v59
v_cvt_pk_bf16_f32 v154, v60, v61
v_mfma_f32_16x16x32_bf16 v[48:51], a[184:187], a[172:175], 0
ds_read_b128 a[224:227], v14 offset:39968
v_cvt_pk_bf16_f32 v155, v62, v63
v_mfma_f32_16x16x32_bf16 v[48:51], a[192:195], a[176:179], v[48:51]
ds_read_b128 a[228:231], v10 offset:39936
v_cvt_pk_bf16_f32 v158, v64, v65
v_mfma_f32_16x16x32_bf16 v[52:55], a[192:195], a[180:183], 0
ds_read_b128 a[232:235], v9 offset:40000
v_cvt_pk_bf16_f32 v159, v66, v67
v_mfma_f32_16x16x32_bf16 v[52:55], a[188:191], a[172:175], v[52:55]
ds_read_b128 a[236:239], v14 offset:40032
s_waitcnt lgkmcnt(8)
v_mfma_f32_16x16x32_bf16 v[56:59], a[196:199], a[172:175], 0
ds_read_b128 a[240:243], v10 offset:40000
v_cvt_pk_bf16_f32 v160, v48, v49
v_mfma_f32_16x16x32_bf16 v[56:59], a[204:207], a[176:179], v[56:59]
ds_read_b128 a[184:187], v9 offset:40064
v_cvt_pk_bf16_f32 v161, v50, v51
v_mfma_f32_16x16x32_bf16 v[60:63], a[204:207], a[180:183], 0
ds_read_b128 a[188:191], v14 offset:40096
v_cvt_pk_bf16_f32 v164, v52, v53
v_mfma_f32_16x16x32_bf16 v[60:63], a[200:203], a[172:175], v[60:63]
ds_read_b128 a[192:195], v10 offset:40064
s_waitcnt lgkmcnt(9)
v_mfma_f32_16x16x32_bf16 v[64:67], a[208:211], a[172:175], 0
v_cvt_pk_bf16_f32 v165, v54, v55
v_add_u32 v9, 55296, v9
v_mfma_f32_16x16x32_bf16 v[64:67], a[216:219], a[176:179], v[64:67]
v_add_u32 v10, 55296, v10
v_cvt_pk_bf16_f32 v168, v56, v57
v_mfma_f32_16x16x32_bf16 v[48:51], a[216:219], a[180:183], 0
v_add_u32 v14, 55296, v14
v_cvt_pk_bf16_f32 v169, v58, v59
v_mfma_f32_16x16x32_bf16 v[48:51], a[212:215], a[172:175], v[48:51]
s_waitcnt lgkmcnt(6)
v_cvt_pk_bf16_f32 v172, v60, v61
v_cvt_pk_bf16_f32 v173, v62, v63
v_mfma_f32_16x16x32_bf16 v[52:55], a[220:223], a[172:175], 0
s_waitcnt lgkmcnt(0)
s_barrier
v_cvt_pk_bf16_f32 v176, v64, v65
v_mfma_f32_16x16x32_bf16 v[52:55], a[228:231], a[176:179], v[52:55]
ds_read_b128 a[196:199], v9 offset:0
v_cvt_pk_bf16_f32 v177, v66, v67
v_mfma_f32_16x16x32_bf16 v[56:59], a[228:231], a[180:183], 0
ds_read_b128 a[200:203], v14 offset:32
v_cvt_pk_bf16_f32 v180, v48, v49
v_mfma_f32_16x16x32_bf16 v[56:59], a[224:227], a[172:175], v[56:59]
ds_read_b128 a[204:207], v10 offset:0
v_cvt_pk_bf16_f32 v181, v50, v51
v_mfma_f32_16x16x32_bf16 v[60:63], a[232:235], a[172:175], 0
ds_read_b128 a[208:211], v9 offset:64
v_cvt_pk_bf16_f32 v162, v52, v53
v_mfma_f32_16x16x32_bf16 v[60:63], a[240:243], a[176:179], v[60:63]
ds_read_b128 a[212:215], v14 offset:96
v_cvt_pk_bf16_f32 v163, v54, v55
v_mfma_f32_16x16x32_bf16 v[64:67], a[240:243], a[180:183], 0
ds_read_b128 a[216:219], v10 offset:64
v_cvt_pk_bf16_f32 v166, v56, v57
v_mfma_f32_16x16x32_bf16 v[64:67], a[236:239], a[172:175], v[64:67]
ds_read_b128 a[220:223], v9 offset:128
v_cvt_pk_bf16_f32 v167, v58, v59
v_mfma_f32_16x16x32_bf16 v[48:51], a[184:187], a[172:175], 0
ds_read_b128 a[224:227], v14 offset:160
v_cvt_pk_bf16_f32 v170, v60, v61
v_mfma_f32_16x16x32_bf16 v[48:51], a[192:195], a[176:179], v[48:51]
ds_read_b128 a[228:231], v10 offset:128
v_cvt_pk_bf16_f32 v171, v62, v63
v_mfma_f32_16x16x32_bf16 v[52:55], a[192:195], a[180:183], 0
ds_read_b128 a[232:235], v9 offset:3072
v_cvt_pk_bf16_f32 v174, v64, v65
v_mfma_f32_16x16x32_bf16 v[52:55], a[188:191], a[172:175], v[52:55]
s_waitcnt lgkmcnt(7)
v_cvt_pk_bf16_f32 v175, v66, v67
v_cvt_pk_bf16_f32 v178, v48, v49
v_mfma_f32_16x16x32_bf16 v[56:59], a[196:199], a[172:175], 0
ds_read_b128 a[236:239], v14 offset:3104
v_cvt_pk_bf16_f32 v179, v50, v51
v_mfma_f32_16x16x32_bf16 v[56:59], a[204:207], a[176:179], v[56:59]
ds_read_b128 a[240:243], v10 offset:3072
v_cvt_pk_bf16_f32 v182, v52, v53
v_mfma_f32_16x16x32_bf16 v[60:63], a[204:207], a[180:183], 0
ds_read_b128 a[184:187], v9 offset:3136
v_cvt_pk_bf16_f32 v183, v54, v55
v_mfma_f32_16x16x32_bf16 v[60:63], a[200:203], a[172:175], v[60:63]
ds_read_b128 a[188:191], v14 offset:3168
s_waitcnt lgkmcnt(8)
v_mfma_f32_16x16x32_bf16 v[64:67], a[208:211], a[172:175], 0
ds_read_b128 a[192:195], v10 offset:3136
v_cvt_pk_bf16_f32 v184, v56, v57
v_mfma_f32_16x16x32_bf16 v[64:67], a[216:219], a[176:179], v[64:67]
ds_read_b128 a[196:199], v9 offset:3200
v_cvt_pk_bf16_f32 v185, v58, v59
v_mfma_f32_16x16x32_bf16 v[48:51], a[216:219], a[180:183], 0
ds_read_b128 a[200:203], v14 offset:3232
v_cvt_pk_bf16_f32 v188, v60, v61
v_mfma_f32_16x16x32_bf16 v[48:51], a[212:215], a[172:175], v[48:51]
s_waitcnt lgkmcnt(8)
v_cvt_pk_bf16_f32 v189, v62, v63
v_cvt_pk_bf16_f32 v192, v64, v65
v_mfma_f32_16x16x32_bf16 v[52:55], a[220:223], a[172:175], 0
ds_read_b128 a[204:207], v10 offset:3200
v_cvt_pk_bf16_f32 v193, v66, v67
v_mfma_f32_16x16x32_bf16 v[52:55], a[228:231], a[176:179], v[52:55]
v_mfma_f32_16x16x32_bf16 v[56:59], a[228:231], a[180:183], 0
v_cvt_pk_bf16_f32 v196, v48, v49
v_cvt_pk_bf16_f32 v197, v50, v51
v_mfma_f32_16x16x32_bf16 v[56:59], a[224:227], a[172:175], v[56:59]
s_barrier
s_waitcnt lgkmcnt(6)
v_mfma_f32_16x16x32_bf16 v[60:63], a[232:235], a[172:175], 0
ds_read_b128 a[208:211], v9 offset:18432
v_cvt_pk_bf16_f32 v200, v52, v53
v_mfma_f32_16x16x32_bf16 v[60:63], a[240:243], a[176:179], v[60:63]
ds_read_b128 a[212:215], v14 offset:18464
v_cvt_pk_bf16_f32 v201, v54, v55
v_mfma_f32_16x16x32_bf16 v[64:67], a[240:243], a[180:183], 0
ds_read_b128 a[216:219], v10 offset:18432
v_cvt_pk_bf16_f32 v204, v56, v57
v_mfma_f32_16x16x32_bf16 v[64:67], a[236:239], a[172:175], v[64:67]
ds_read_b128 a[220:223], v9 offset:18496
s_waitcnt lgkmcnt(7)
v_mfma_f32_16x16x32_bf16 v[48:51], a[184:187], a[172:175], 0
ds_read_b128 a[224:227], v14 offset:18528
v_cvt_pk_bf16_f32 v205, v58, v59
v_mfma_f32_16x16x32_bf16 v[48:51], a[192:195], a[176:179], v[48:51]
LpgD0:
s_cbranch_vccnz Lpg1done
ds_read_b128 a[228:231], v10 offset:18496
v_cvt_pk_bf16_f32 v186, v60, v61
v_mfma_f32_16x16x32_bf16 v[52:55], a[192:195], a[180:183], 0
ds_read_b128 a[232:235], v9 offset:18560
v_cvt_pk_bf16_f32 v187, v62, v63
v_mfma_f32_16x16x32_bf16 v[52:55], a[188:191], a[172:175], v[52:55]
s_waitcnt lgkmcnt(7)
v_cvt_pk_bf16_f32 v190, v64, v65
v_cvt_pk_bf16_f32 v191, v66, v67
v_mfma_f32_16x16x32_bf16 v[56:59], a[196:199], a[172:175], 0
ds_read_b128 a[236:239], v14 offset:18592
v_cvt_pk_bf16_f32 v194, v48, v49
v_mfma_f32_16x16x32_bf16 v[56:59], a[204:207], a[176:179], v[56:59]
ds_read_b128 a[240:243], v10 offset:18560
v_cvt_pk_bf16_f32 v195, v50, v51
v_mfma_f32_16x16x32_bf16 v[60:63], a[204:207], a[180:183], 0
ds_read_b128 a[184:187], v9 offset:21504
v_cvt_pk_bf16_f32 v198, v52, v53
v_mfma_f32_16x16x32_bf16 v[60:63], a[200:203], a[172:175], v[60:63]
s_waitcnt lgkmcnt(7)
v_cvt_pk_bf16_f32 v199, v54, v55
v_cvt_pk_bf16_f32 v202, v56, v57
v_mfma_f32_16x16x32_bf16 v[64:67], a[208:211], a[172:175], 0
ds_read_b128 a[188:191], v14 offset:21536
v_cvt_pk_bf16_f32 v203, v58, v59
v_mfma_f32_16x16x32_bf16 v[64:67], a[216:219], a[176:179], v[64:67]
ds_read_b128 a[192:195], v10 offset:21504
v_cvt_pk_bf16_f32 v206, v60, v61
v_mfma_f32_16x16x32_bf16 v[48:51], a[216:219], a[180:183], 0
ds_read_b128 a[196:199], v9 offset:21568
v_cvt_pk_bf16_f32 v207, v62, v63
v_mfma_f32_16x16x32_bf16 v[48:51], a[212:215], a[172:175], v[48:51]
ds_read_b128 a[200:203], v14 offset:21600
s_waitcnt lgkmcnt(8)
v_mfma_f32_16x16x32_bf16 v[52:55], a[220:223], a[172:175], 0
ds_read_b128 a[204:207], v10 offset:21568
v_cvt_pk_bf16_f32 v208, v64, v65
v_mfma_f32_16x16x32_bf16 v[52:55], a[228:231], a[176:179], v[52:55]
ds_read_b128 a[208:211], v9 offset:21632
v_cvt_pk_bf16_f32 v209, v66, v67
v_mfma_f32_16x16x32_bf16 v[56:59], a[228:231], a[180:183], 0
ds_read_b128 a[212:215], v14 offset:21664
v_cvt_pk_bf16_f32 v212, v48, v49
v_mfma_f32_16x16x32_bf16 v[56:59], a[224:227], a[172:175], v[56:59]
s_waitcnt lgkmcnt(8)
v_cvt_pk_bf16_f32 v213, v50, v51
v_cvt_pk_bf16_f32 v216, v52, v53
v_mfma_f32_16x16x32_bf16 v[60:63], a[232:235], a[172:175], 0
ds_read_b128 a[216:219], v10 offset:21632
v_cvt_pk_bf16_f32 v217, v54, v55
v_mfma_f32_16x16x32_bf16 v[60:63], a[240:243], a[176:179], v[60:63]
v_mfma_f32_16x16x32_bf16 v[64:67], a[240:243], a[180:183], 0
v_cvt_pk_bf16_f32 v220, v56, v57
v_cvt_pk_bf16_f32 v221, v58, v59
v_mfma_f32_16x16x32_bf16 v[64:67], a[236:239], a[172:175], v[64:67]
s_barrier
s_waitcnt lgkmcnt(6)
v_mfma_f32_16x16x32_bf16 v[48:51], a[184:187], a[172:175], 0
ds_read_b128 a[220:223], v9 offset:36864
v_cvt_pk_bf16_f32 v224, v60, v61
v_mfma_f32_16x16x32_bf16 v[48:51], a[192:195], a[176:179], v[48:51]
ds_read_b128 a[224:227], v14 offset:36896
v_cvt_pk_bf16_f32 v225, v62, v63
v_mfma_f32_16x16x32_bf16 v[52:55], a[192:195], a[180:183], 0
ds_read_b128 a[228:231], v10 offset:36864
v_cvt_pk_bf16_f32 v228, v64, v65
v_mfma_f32_16x16x32_bf16 v[52:55], a[188:191], a[172:175], v[52:55]
ds_read_b128 a[232:235], v9 offset:36928
s_waitcnt lgkmcnt(7)
v_mfma_f32_16x16x32_bf16 v[56:59], a[196:199], a[172:175], 0
ds_read_b128 a[236:239], v14 offset:36960
v_cvt_pk_bf16_f32 v229, v66, v67
v_mfma_f32_16x16x32_bf16 v[56:59], a[204:207], a[176:179], v[56:59]
ds_read_b128 a[240:243], v10 offset:36928
v_cvt_pk_bf16_f32 v210, v48, v49
v_mfma_f32_16x16x32_bf16 v[60:63], a[204:207], a[180:183], 0
ds_read_b128 a[184:187], v9 offset:36992
v_cvt_pk_bf16_f32 v211, v50, v51
v_mfma_f32_16x16x32_bf16 v[60:63], a[200:203], a[172:175], v[60:63]
s_waitcnt lgkmcnt(7)
v_cvt_pk_bf16_f32 v214, v52, v53
v_cvt_pk_bf16_f32 v215, v54, v55
v_mfma_f32_16x16x32_bf16 v[64:67], a[208:211], a[172:175], 0
ds_read_b128 a[188:191], v14 offset:37024
v_cvt_pk_bf16_f32 v218, v56, v57
v_mfma_f32_16x16x32_bf16 v[64:67], a[216:219], a[176:179], v[64:67]
ds_read_b128 a[192:195], v10 offset:36992
v_cvt_pk_bf16_f32 v219, v58, v59
v_mfma_f32_16x16x32_bf16 v[48:51], a[216:219], a[180:183], 0
ds_read_b128 a[196:199], v9 offset:39936
v_cvt_pk_bf16_f32 v222, v60, v61
v_mfma_f32_16x16x32_bf16 v[48:51], a[212:215], a[172:175], v[48:51]
s_waitcnt lgkmcnt(7)
v_cvt_pk_bf16_f32 v223, v62, v63
v_cvt_pk_bf16_f32 v226, v64, v65
v_mfma_f32_16x16x32_bf16 v[52:55], a[220:223], a[172:175], 0
ds_read_b128 a[200:203], v14 offset:39968
v_cvt_pk_bf16_f32 v227, v66, v67
v_mfma_f32_16x16x32_bf16 v[52:55], a[228:231], a[176:179], v[52:55]
ds_read_b128 a[204:207], v10 offset:39936
v_cvt_pk_bf16_f32 v230, v48, v49
v_mfma_f32_16x16x32_bf16 v[56:59], a[228:231], a[180:183], 0
ds_read_b128 a[208:211], v9 offset:40000
v_cvt_pk_bf16_f32 v231, v50, v51
v_mfma_f32_16x16x32_bf16 v[56:59], a[224:227], a[172:175], v[56:59]
ds_read_b128 a[212:215], v14 offset:40032
s_waitcnt lgkmcnt(8)
v_mfma_f32_16x16x32_bf16 v[60:63], a[232:235], a[172:175], 0
ds_read_b128 a[216:219], v10 offset:40000
v_cvt_pk_bf16_f32 v232, v52, v53
v_mfma_f32_16x16x32_bf16 v[60:63], a[240:243], a[176:179], v[60:63]
ds_read_b128 a[220:223], v9 offset:40064
v_cvt_pk_bf16_f32 v233, v54, v55
v_mfma_f32_16x16x32_bf16 v[64:67], a[240:243], a[180:183], 0
ds_read_b128 a[224:227], v14 offset:40096
v_cvt_pk_bf16_f32 v236, v56, v57
v_mfma_f32_16x16x32_bf16 v[64:67], a[236:239], a[172:175], v[64:67]
s_waitcnt lgkmcnt(8)
v_cvt_pk_bf16_f32 v237, v58, v59
v_cvt_pk_bf16_f32 v240, v60, v61
v_mfma_f32_16x16x32_bf16 v[48:51], a[184:187], a[172:175], 0
ds_read_b128 a[228:231], v10 offset:40064
v_cvt_pk_bf16_f32 v241, v62, v63
v_mfma_f32_16x16x32_bf16 v[48:51], a[192:195], a[176:179], v[48:51]
v_mfma_f32_16x16x32_bf16 v[52:55], a[192:195], a[180:183], 0
v_cvt_pk_bf16_f32 v244, v64, v65
v_cvt_pk_bf16_f32 v245, v66, v67
v_mfma_f32_16x16x32_bf16 v[52:55], a[188:191], a[172:175], v[52:55]
s_waitcnt lgkmcnt(6)
v_mfma_f32_16x16x32_bf16 v[56:59], a[196:199], a[172:175], 0
v_cvt_pk_bf16_f32 v248, v48, v49
v_cvt_pk_bf16_f32 v249, v50, v51
v_mfma_f32_16x16x32_bf16 v[56:59], a[204:207], a[176:179], v[56:59]
v_mfma_f32_16x16x32_bf16 v[60:63], a[204:207], a[180:183], 0
v_cvt_pk_bf16_f32 v252, v52, v53
v_cvt_pk_bf16_f32 v253, v54, v55
v_mfma_f32_16x16x32_bf16 v[60:63], a[200:203], a[172:175], v[60:63]
s_waitcnt lgkmcnt(3)
v_mfma_f32_16x16x32_bf16 v[64:67], a[208:211], a[172:175], 0
v_cvt_pk_bf16_f32 v234, v56, v57
v_cvt_pk_bf16_f32 v235, v58, v59
v_mfma_f32_16x16x32_bf16 v[64:67], a[216:219], a[176:179], v[64:67]
v_mfma_f32_16x16x32_bf16 v[48:51], a[216:219], a[180:183], 0
v_cvt_pk_bf16_f32 v238, v60, v61
v_cvt_pk_bf16_f32 v239, v62, v63
v_mfma_f32_16x16x32_bf16 v[48:51], a[212:215], a[172:175], v[48:51]
s_waitcnt lgkmcnt(0)
v_mfma_f32_16x16x32_bf16 v[52:55], a[220:223], a[172:175], 0
v_cvt_pk_bf16_f32 v242, v64, v65
v_cvt_pk_bf16_f32 v243, v66, v67
v_mfma_f32_16x16x32_bf16 v[52:55], a[228:231], a[176:179], v[52:55]
s_barrier
v_cvt_pk_bf16_f32 v246, v48, v49
ds_read_b128 a[144:147], v1 offset:0
v_mfma_f32_16x16x32_bf16 v[56:59], a[228:231], a[180:183], 0
ds_read_b128 a[148:151], v2 offset:0
v_cvt_pk_bf16_f32 v247, v50, v51
ds_read_b128 a[152:155], v3 offset:0
v_mfma_f32_16x16x32_bf16 v[56:59], a[224:227], a[172:175], v[56:59]
ds_read_b128 a[156:159], v4 offset:0
v_cvt_pk_bf16_f32 v250, v52, v53
ds_read_b128 a[160:163], v1 offset:128
ds_read_b128 a[164:167], v2 offset:128
v_cvt_pk_bf16_f32 v251, v54, v55
s_nop 0
s_nop 0
s_nop 0
s_nop 0
v_cvt_pk_bf16_f32 v254, v56, v57
v_cvt_pk_bf16_f32 v255, v58, v59
s_waitcnt lgkmcnt(4)
v_mfma_f32_16x16x32_bf16 v[48:51], a[168:171], a[144:147], 0
v_mfma_f32_16x16x32_bf16 v[52:55], a[168:171], a[148:151], 0
s_waitcnt lgkmcnt(2)
v_mfma_f32_16x16x32_bf16 v[56:59], a[168:171], a[152:155], 0
v_mfma_f32_16x16x32_bf16 v[60:63], a[168:171], a[156:159], 0
v_cvt_pk_bf16_f32 v24, v48, v49
v_cvt_pk_bf16_f32 v25, v50, v51
v_cvt_pk_bf16_f32 v26, v52, v53
s_waitcnt lgkmcnt(0)
v_mfma_f32_16x16x32_bf16 v[48:51], a[168:171], a[160:163], 0
v_cvt_pk_bf16_f32 v27, v54, v55
v_cvt_pk_bf16_f32 v28, v56, v57
v_cvt_pk_bf16_f32 v29, v58, v59
v_mfma_f32_16x16x32_bf16 v[52:55], a[168:171], a[164:167], 0
s_barrier
v_cvt_pk_bf16_f32 v30, v60, v61
ds_read_b128 a[144:147], v1 offset:6528
v_mfma_f32_16x16x32_bf16 a[72:75], a[0:3], v[24:27], 0
ds_read_b128 a[148:151], v2 offset:6528
v_cvt_pk_bf16_f32 v31, v62, v63
v_cvt_pk_bf16_f32 v32, v48, v49
s_nop 0
v_mfma_f32_16x16x32_bf16 a[72:75], v[20:23], v[28:31], a[72:75]
ds_read_b128 a[152:155], v3 offset:6528
v_cvt_pk_bf16_f32 v33, v50, v51
v_cvt_pk_bf16_f32 v34, v52, v53
v_cvt_pk_bf16_f32 v35, v54, v55
s_nop 1
v_mfma_f32_16x16x32_bf16 a[72:75], v[88:91], v[32:35], a[72:75]
ds_read_b128 a[156:159], v4 offset:6528
v_mfma_f32_16x16x32_bf16 a[76:79], v[92:95], v[32:35], 0
v_mfma_f32_16x16x32_bf16 a[76:79], v[68:71], v[28:31], a[76:79]
v_mfma_f32_16x16x32_bf16 a[76:79], a[4:7], v[24:27], a[76:79]
ds_read_b128 a[160:163], v1 offset:6656
s_waitcnt lgkmcnt(3)
v_mfma_f32_16x16x32_bf16 v[48:51], a[168:171], a[144:147], 0
ds_read_b128 a[164:167], v2 offset:6656
v_add_u32 v1, 13056, v1
v_mfma_f32_16x16x32_bf16 v[52:55], a[168:171], a[148:151], 0
v_mfma_f32_16x16x32_bf16 a[80:83], a[8:11], v[24:27], 0
v_mfma_f32_16x16x32_bf16 a[80:83], v[72:75], v[28:31], a[80:83]
v_cvt_pk_bf16_f32 v36, v48, v49
v_cvt_pk_bf16_f32 v37, v50, v51
v_mfma_f32_16x16x32_bf16 a[80:83], v[96:99], v[32:35], a[80:83]
s_waitcnt lgkmcnt(2)
v_cvt_pk_bf16_f32 v38, v52, v53
v_cvt_pk_bf16_f32 v39, v54, v55
v_mfma_f32_16x16x32_bf16 v[56:59], a[168:171], a[152:155], 0
s_cmp_ge_u32 s39, s43
s_cselect_b32 s44, 2.0, s36
v_mfma_f32_16x16x32_bf16 v[60:63], a[168:171], a[156:159], 0
s_mov_b32 m0, s40
s_cmp_eq_u32 s38, s42
s_cselect_b32 s45, 2.0, 0
v_mfma_f32_16x16x32_bf16 a[84:87], v[100:103], v[32:35], 0
buffer_load_dwordx4 v5, s[12:15], s44 offen offset:0 nt lds
v_mfma_f32_16x16x32_bf16 a[84:87], v[76:79], v[28:31], a[84:87]
v_cvt_pk_bf16_f32 v40, v56, v57
v_cvt_pk_bf16_f32 v41, v58, v59
v_mfma_f32_16x16x32_bf16 a[84:87], a[12:15], v[24:27], a[84:87]
s_waitcnt lgkmcnt(0)
v_cvt_pk_bf16_f32 v42, v60, v61
v_cvt_pk_bf16_f32 v43, v62, v63
v_mfma_f32_16x16x32_bf16 v[48:51], a[168:171], a[160:163], 0
buffer_load_dwordx4 v6, s[12:15], s44 offen offset:1024 nt lds
v_mfma_f32_16x16x32_bf16 v[52:55], a[168:171], a[164:167], 0
buffer_load_dwordx4 v7, s[12:15], s44 offen offset:2048 nt lds
v_mfma_f32_16x16x32_bf16 a[88:91], a[16:19], v[24:27], 0
v_mfma_f32_16x16x32_bf16 a[88:91], v[80:83], v[28:31], a[88:91]
v_cvt_pk_bf16_f32 v44, v48, v49
v_cvt_pk_bf16_f32 v45, v50, v51
v_mfma_f32_16x16x32_bf16 a[88:91], v[104:107], v[32:35], a[88:91]
v_cvt_pk_bf16_f32 v46, v52, v53
v_cvt_pk_bf16_f32 v47, v54, v55
v_mfma_f32_16x16x32_bf16 a[92:95], v[108:111], v[32:35], 0
s_add_u32 m0, s40, s41
s_add_u32 s37, s37, 1
s_add_u32 s39, s39, 1
v_mfma_f32_16x16x32_bf16 a[92:95], v[84:87], v[28:31], a[92:95]
v_and_or_b32 v13, v12, s45, v8
v_mfma_f32_16x16x32_bf16 a[92:95], v[16:19], v[24:27], a[92:95]
buffer_load_dword v13, s[12:15], s44 offen nt lds
v_mfma_f32_16x16x32_bf16 a[96:99], v[112:115], v[36:39], a[72:75]
s_cmp_eq_u32 s37, 384
s_cselect_b32 s37, 0, s37
s_addc_u32 s38, s38, 0
v_mfma_f32_16x16x32_bf16 a[96:99], v[136:139], v[40:43], a[96:99]
s_barrier
v_mfma_f32_16x16x32_bf16 a[96:99], v[160:163], v[44:47], a[96:99]
ds_read_b128 a[144:147], v1 offset:0
v_add_u32 v2, 13056, v2
v_mfma_f32_16x16x32_bf16 a[100:103], v[164:167], v[44:47], a[76:79]
s_cmp_eq_u32 s37, 0
s_cselect_b32 s49, -28231680, s48
s_add_u32 s36, s36, s49
v_mfma_f32_16x16x32_bf16 a[100:103], v[140:143], v[40:43], a[100:103]
ds_read_b128 a[148:151], v2 offset:0
v_add_u32 v3, 13056, v3
v_mfma_f32_16x16x32_bf16 a[100:103], v[116:119], v[36:39], a[100:103]
s_add_u32 s40, s40, 6528
s_min_u32 s40, s40, s47
v_mfma_f32_16x16x32_bf16 a[104:107], v[120:123], v[36:39], a[80:83]
s_cmp_ge_u32 s39, s43
s_cselect_b32 s44, 2.0, s36
v_mfma_f32_16x16x32_bf16 a[104:107], v[144:147], v[40:43], a[104:107]
ds_read_b128 a[152:155], v3 offset:0
v_add_u32 v4, 13056, v4
v_mfma_f32_16x16x32_bf16 a[104:107], v[168:171], v[44:47], a[104:107]
s_mov_b32 m0, s40
s_cmp_eq_u32 s38, s42
s_cselect_b32 s45, 2.0, 0
v_mfma_f32_16x16x32_bf16 a[108:111], v[172:175], v[44:47], a[84:87]
buffer_load_dwordx4 v5, s[12:15], s44 offen offset:0 nt lds
v_mfma_f32_16x16x32_bf16 a[108:111], v[148:151], v[40:43], a[108:111]
ds_read_b128 a[156:159], v4 offset:0
v_mfma_f32_16x16x32_bf16 a[108:111], v[124:127], v[36:39], a[108:111]
ds_read_b128 a[160:163], v1 offset:128
s_waitcnt lgkmcnt(3)
v_mfma_f32_16x16x32_bf16 v[48:51], a[168:171], a[144:147], 0
buffer_load_dwordx4 v6, s[12:15], s44 offen offset:1024 nt lds
v_mfma_f32_16x16x32_bf16 v[52:55], a[168:171], a[148:151], 0
buffer_load_dwordx4 v7, s[12:15], s44 offen offset:2048 nt lds
v_mfma_f32_16x16x32_bf16 a[112:115], v[128:131], v[36:39], a[88:91]
s_add_u32 m0, s40, s41
s_add_u32 s37, s37, 1
s_add_u32 s39, s39, 1
v_mfma_f32_16x16x32_bf16 a[112:115], v[152:155], v[40:43], a[112:115]
ds_read_b128 a[164:167], v2 offset:128
v_and_or_b32 v13, v12, s45, v8
v_mfma_f32_16x16x32_bf16 a[112:115], v[176:179], v[44:47], a[112:115]
s_waitcnt lgkmcnt(2)
v_cvt_pk_bf16_f32 v24, v48, v49
v_cvt_pk_bf16_f32 v25, v50, v51
v_mfma_f32_16x16x32_bf16 v[56:59], a[168:171], a[152:155], 0
buffer_load_dword v13, s[12:15], s44 offen nt lds
v_mfma_f32_16x16x32_bf16 v[60:63], a[168:171], a[156:159], 0
s_cmp_eq_u32 s37, 384
s_cselect_b32 s37, 0, s37
s_addc_u32 s38, s38, 0
v_mfma_f32_16x16x32_bf16 a[116:119], v[180:183], v[44:47], a[92:95]
s_cmp_eq_u32 s37, 0
s_cselect_b32 s49, -28231680, s48
s_add_u32 s36, s36, s49
v_mfma_f32_16x16x32_bf16 a[116:119], v[156:159], v[40:43], a[116:119]
s_add_u32 s40, s40, 6528
s_min_u32 s40, s40, s47
v_cvt_pk_bf16_f32 v26, v52, v53
v_mfma_f32_16x16x32_bf16 a[116:119], v[132:135], v[36:39], a[116:119]
s_cmp_ge_u32 s39, s43
s_cselect_b32 s44, 2.0, s36
s_waitcnt lgkmcnt(0)
v_mfma_f32_16x16x32_bf16 v[48:51], a[168:171], a[160:163], 0
s_mov_b32 m0, s40
s_cmp_eq_u32 s38, s42
s_cselect_b32 s45, 2.0, 0
buffer_load_dwordx4 v5, s[12:15], s44 offen offset:0 nt lds
buffer_load_dwordx4 v6, s[12:15], s44 offen offset:1024 nt lds
v_cvt_pk_bf16_f32 v27, v54, v55
v_mfma_f32_16x16x32_bf16 v[52:55], a[168:171], a[164:167], 0
buffer_load_dwordx4 v7, s[12:15], s44 offen offset:2048 nt lds
v_mfma_f32_16x16x32_bf16 a[72:75], a[0:3], v[36:39], 0
s_add_u32 m0, s40, s41
s_add_u32 s37, s37, 1
s_add_u32 s39, s39, 1
v_mfma_f32_16x16x32_bf16 a[72:75], v[20:23], v[40:43], a[72:75]
v_cvt_pk_bf16_f32 v28, v56, v57
v_and_or_b32 v13, v12, s45, v8
v_mfma_f32_16x16x32_bf16 a[72:75], v[88:91], v[44:47], a[72:75]
v_cvt_pk_bf16_f32 v29, v58, v59
v_cvt_pk_bf16_f32 v30, v60, v61
v_mfma_f32_16x16x32_bf16 a[76:79], v[92:95], v[44:47], 0
buffer_load_dword v13, s[12:15], s44 offen nt lds
v_mfma_f32_16x16x32_bf16 a[76:79], v[68:71], v[40:43], a[76:79]
v_cvt_pk_bf16_f32 v31, v62, v63
v_cvt_pk_bf16_f32 v32, v48, v49
v_mfma_f32_16x16x32_bf16 a[76:79], a[4:7], v[36:39], a[76:79]
s_cmp_eq_u32 s37, 384
s_cselect_b32 s37, 0, s37
s_addc_u32 s38, s38, 0
v_mfma_f32_16x16x32_bf16 a[80:83], a[8:11], v[36:39], 0
s_cmp_eq_u32 s37, 0
s_cselect_b32 s49, -28231680, s48
s_add_u32 s36, s36, s49
v_mfma_f32_16x16x32_bf16 a[80:83], v[72:75], v[40:43], a[80:83]
s_add_u32 s40, s40, 6528
s_min_u32 s40, s40, s47
v_cvt_pk_bf16_f32 v33, v50, v51
v_mfma_f32_16x16x32_bf16 a[80:83], v[96:99], v[44:47], a[80:83]
v_cvt_pk_bf16_f32 v34, v52, v53
v_cvt_pk_bf16_f32 v35, v54, v55
v_mfma_f32_16x16x32_bf16 a[84:87], v[100:103], v[44:47], 0
v_mfma_f32_16x16x32_bf16 a[84:87], v[76:79], v[40:43], a[84:87]
v_mfma_f32_16x16x32_bf16 a[84:87], a[12:15], v[36:39], a[84:87]
v_mfma_f32_16x16x32_bf16 a[88:91], a[16:19], v[36:39], 0
v_mfma_f32_16x16x32_bf16 a[88:91], v[80:83], v[40:43], a[88:91]
v_mfma_f32_16x16x32_bf16 a[88:91], v[104:107], v[44:47], a[88:91]
v_mfma_f32_16x16x32_bf16 a[92:95], v[108:111], v[44:47], 0
v_mfma_f32_16x16x32_bf16 a[92:95], v[84:87], v[40:43], a[92:95]
v_mfma_f32_16x16x32_bf16 a[92:95], v[16:19], v[36:39], a[92:95]
s_barrier
s_nop 1
s_mov_b32 s46, 2
.p2align 6, , 60
LP_loop:
v_mfma_f32_16x16x32_bf16 a[120:123], v[184:187], v[24:27], a[96:99]
v_mfma_f32_16x16x32_bf16 a[120:123], v[208:211], v[28:31], a[120:123]
v_mfma_f32_16x16x32_bf16 a[120:123], v[232:235], v[32:35], a[120:123]
v_mfma_f32_16x16x32_bf16 a[124:127], v[236:239], v[32:35], a[100:103]
v_mfma_f32_16x16x32_bf16 a[124:127], v[212:215], v[28:31], a[124:127]
v_mfma_f32_16x16x32_bf16 a[124:127], v[188:191], v[24:27], a[124:127]
v_mfma_f32_16x16x32_bf16 a[128:131], v[192:195], v[24:27], a[104:107]
v_mfma_f32_16x16x32_bf16 a[128:131], v[216:219], v[28:31], a[128:131]
ds_read_b128 a[144:147], v1 offset:6528
v_mfma_f32_16x16x32_bf16 a[128:131], v[240:243], v[32:35], a[128:131]
ds_read_b128 a[148:151], v2 offset:6528
v_mfma_f32_16x16x32_bf16 a[132:135], v[244:247], v[32:35], a[108:111]
ds_read_b128 a[152:155], v3 offset:6528
v_mfma_f32_16x16x32_bf16 a[132:135], v[220:223], v[28:31], a[132:135]
ds_read_b128 a[156:159], v4 offset:6528
v_mfma_f32_16x16x32_bf16 a[132:135], v[196:199], v[24:27], a[132:135]
v_mfma_f32_16x16x32_bf16 a[136:139], v[200:203], v[24:27], a[112:115]
v_mfma_f32_16x16x32_bf16 a[136:139], v[224:227], v[28:31], a[136:139]
v_mfma_f32_16x16x32_bf16 a[136:139], v[248:251], v[32:35], a[136:139]
ds_read_b128 a[160:163], v1 offset:6656
v_mfma_f32_16x16x32_bf16 a[140:143], v[252:255], v[32:35], a[116:119]
ds_read_b128 a[164:167], v2 offset:6656
v_add_u32 v1, 13056, v1
v_mfma_f32_16x16x32_bf16 a[140:143], v[228:231], v[28:31], a[140:143]
v_mfma_f32_16x16x32_bf16 a[140:143], v[204:207], v[24:27], a[140:143]
s_waitcnt lgkmcnt(4)
v_mfma_f32_16x16x32_bf16 v[48:51], a[168:171], a[144:147], 0
v_mfma_f32_16x16x32_bf16 v[52:55], a[168:171], a[148:151], 0
s_waitcnt lgkmcnt(2)
v_mfma_f32_16x16x32_bf16 v[56:59], a[168:171], a[152:155], 0
ds_write_b128 v11, a[120:123] offset:0
v_mfma_f32_16x16x32_bf16 v[60:63], a[168:171], a[156:159], 0
v_cvt_pk_bf16_f32 v36, v48, v49
v_cvt_pk_bf16_f32 v37, v50, v51
v_mfma_f32_16x16x32_bf16 a[96:99], v[112:115], v[24:27], a[72:75]
ds_write_b128 v11, a[124:127] offset:1024
v_mfma_f32_16x16x32_bf16 a[96:99], v[136:139], v[28:31], a[96:99]
v_cvt_pk_bf16_f32 v38, v52, v53
v_cvt_pk_bf16_f32 v39, v54, v55
v_mfma_f32_16x16x32_bf16 a[96:99], v[160:163], v[32:35], a[96:99]
s_waitcnt lgkmcnt(2)
v_cvt_pk_bf16_f32 v40, v56, v57
v_cvt_pk_bf16_f32 v41, v58, v59
v_mfma_f32_16x16x32_bf16 v[48:51], a[168:171], a[160:163], 0
ds_write_b128 v11, a[128:131] offset:2048
v_mfma_f32_16x16x32_bf16 v[52:55], a[168:171], a[164:167], 0
v_cvt_pk_bf16_f32 v42, v60, v61
v_cvt_pk_bf16_f32 v43, v62, v63
v_mfma_f32_16x16x32_bf16 a[100:103], v[164:167], v[32:35], a[76:79]
ds_write_b128 v11, a[132:135] offset:3072
v_mfma_f32_16x16x32_bf16 a[100:103], v[140:143], v[28:31], a[100:103]
v_cvt_pk_bf16_f32 v44, v48, v49
v_cvt_pk_bf16_f32 v45, v50, v51
v_mfma_f32_16x16x32_bf16 a[100:103], v[116:119], v[24:27], a[100:103]
ds_write_b128 v11, a[136:139] offset:4096
v_mfma_f32_16x16x32_bf16 a[104:107], v[120:123], v[24:27], a[80:83]
v_cvt_pk_bf16_f32 v46, v52, v53
v_cvt_pk_bf16_f32 v47, v54, v55
v_mfma_f32_16x16x32_bf16 a[104:107], v[144:147], v[28:31], a[104:107]
ds_write_b128 v11, a[140:143] offset:5120
v_mfma_f32_16x16x32_bf16 a[104:107], v[168:171], v[32:35], a[104:107]
v_mfma_f32_16x16x32_bf16 a[108:111], v[172:175], v[32:35], a[84:87]
v_mfma_f32_16x16x32_bf16 a[108:111], v[148:151], v[28:31], a[108:111]
v_mfma_f32_16x16x32_bf16 a[108:111], v[124:127], v[24:27], a[108:111]
s_waitcnt vmcnt(8) lgkmcnt(0)
s_barrier
v_mfma_f32_16x16x32_bf16 a[112:115], v[128:131], v[24:27], a[88:91]
v_mfma_f32_16x16x32_bf16 a[112:115], v[152:155], v[28:31], a[112:115]
v_mfma_f32_16x16x32_bf16 a[112:115], v[176:179], v[32:35], a[112:115]
v_mfma_f32_16x16x32_bf16 a[116:119], v[180:183], v[32:35], a[92:95]
s_cmp_ge_u32 s39, s43
s_cselect_b32 s44, 2.0, s36
v_mfma_f32_16x16x32_bf16 a[116:119], v[156:159], v[28:31], a[116:119]
s_mov_b32 m0, s40
s_cmp_eq_u32 s38, s42
s_cselect_b32 s45, 2.0, 0
v_mfma_f32_16x16x32_bf16 a[116:119], v[132:135], v[24:27], a[116:119]
buffer_load_dwordx4 v5, s[12:15], s44 offen offset:0 nt lds
v_mfma_f32_16x16x32_bf16 a[72:75], a[0:3], v[24:27], 0
v_mfma_f32_16x16x32_bf16 a[72:75], v[20:23], v[28:31], a[72:75]
buffer_load_dwordx4 v6, s[12:15], s44 offen offset:1024 nt lds
v_mfma_f32_16x16x32_bf16 a[72:75], v[88:91], v[32:35], a[72:75]
v_mfma_f32_16x16x32_bf16 a[76:79], v[92:95], v[32:35], 0
v_mfma_f32_16x16x32_bf16 a[76:79], v[68:71], v[28:31], a[76:79]
v_mfma_f32_16x16x32_bf16 a[76:79], a[4:7], v[24:27], a[76:79]
buffer_load_dwordx4 v7, s[12:15], s44 offen offset:2048 nt lds
v_mfma_f32_16x16x32_bf16 a[80:83], a[8:11], v[24:27], 0
v_mfma_f32_16x16x32_bf16 a[80:83], v[72:75], v[28:31], a[80:83]
v_mfma_f32_16x16x32_bf16 a[80:83], v[96:99], v[32:35], a[80:83]
v_mfma_f32_16x16x32_bf16 a[84:87], v[100:103], v[32:35], 0
s_add_u32 m0, s40, s41
s_add_u32 s37, s37, 1
s_add_u32 s39, s39, 1
v_mfma_f32_16x16x32_bf16 a[84:87], v[76:79], v[28:31], a[84:87]
v_and_or_b32 v13, v12, s45, v8
v_mfma_f32_16x16x32_bf16 a[84:87], a[12:15], v[24:27], a[84:87]
buffer_load_dword v13, s[12:15], s44 offen nt lds
v_mfma_f32_16x16x32_bf16 a[88:91], a[16:19], v[24:27], 0
v_mfma_f32_16x16x32_bf16 a[88:91], v[80:83], v[28:31], a[88:91]
s_cmp_eq_u32 s37, 384
s_cselect_b32 s37, 0, s37
s_addc_u32 s38, s38, 0
v_mfma_f32_16x16x32_bf16 a[88:91], v[104:107], v[32:35], a[88:91]
s_cmp_eq_u32 s37, 0
s_cselect_b32 s49, -28231680, s48
s_add_u32 s36, s36, s49
v_mfma_f32_16x16x32_bf16 a[92:95], v[108:111], v[32:35], 0
s_add_u32 s40, s40, 6528
s_min_u32 s40, s40, s47
v_mfma_f32_16x16x32_bf16 a[92:95], v[84:87], v[28:31], a[92:95]
v_mfma_f32_16x16x32_bf16 a[92:95], v[16:19], v[24:27], a[92:95]
v_mfma_f32_16x16x32_bf16 a[120:123], v[184:187], v[36:39], a[96:99]
v_mfma_f32_16x16x32_bf16 a[120:123], v[208:211], v[40:43], a[120:123]
v_mfma_f32_16x16x32_bf16 a[120:123], v[232:235], v[44:47], a[120:123]
v_mfma_f32_16x16x32_bf16 a[124:127], v[236:239], v[44:47], a[100:103]
v_mfma_f32_16x16x32_bf16 a[124:127], v[212:215], v[40:43], a[124:127]
v_mfma_f32_16x16x32_bf16 a[124:127], v[188:191], v[36:39], a[124:127]
v_mfma_f32_16x16x32_bf16 a[128:131], v[192:195], v[36:39], a[104:107]
v_mfma_f32_16x16x32_bf16 a[128:131], v[216:219], v[40:43], a[128:131]
ds_read_b128 a[144:147], v1 offset:0
v_add_u32 v2, 13056, v2
v_mfma_f32_16x16x32_bf16 a[128:131], v[240:243], v[44:47], a[128:131]
ds_read_b128 a[148:151], v2 offset:0
v_add_u32 v3, 13056, v3
v_mfma_f32_16x16x32_bf16 a[132:135], v[244:247], v[44:47], a[108:111]
ds_read_b128 a[152:155], v3 offset:0
v_add_u32 v4, 13056, v4
v_mfma_f32_16x16x32_bf16 a[132:135], v[220:223], v[40:43], a[132:135]
ds_read_b128 a[156:159], v4 offset:0
v_mfma_f32_16x16x32_bf16 a[132:135], v[196:199], v[36:39], a[132:135]
v_mfma_f32_16x16x32_bf16 a[136:139], v[200:203], v[36:39], a[112:115]
v_mfma_f32_16x16x32_bf16 a[136:139], v[224:227], v[40:43], a[136:139]
v_mfma_f32_16x16x32_bf16 a[136:139], v[248:251], v[44:47], a[136:139]
ds_read_b128 a[160:163], v1 offset:128
v_mfma_f32_16x16x32_bf16 a[140:143], v[252:255], v[44:47], a[116:119]
ds_read_b128 a[164:167], v2 offset:128
v_mfma_f32_16x16x32_bf16 a[140:143], v[228:231], v[40:43], a[140:143]
s_cmp_eq_u32 s46, s31
v_mfma_f32_16x16x32_bf16 a[140:143], v[204:207], v[36:39], a[140:143]
s_cbranch_scc1 LP_seam
LP_back:
s_waitcnt lgkmcnt(4)
v_mfma_f32_16x16x32_bf16 v[48:51], a[168:171], a[144:147], 0
v_mfma_f32_16x16x32_bf16 v[52:55], a[168:171], a[148:151], 0
s_waitcnt lgkmcnt(2)
v_mfma_f32_16x16x32_bf16 v[56:59], a[168:171], a[152:155], 0
ds_write_b128 v11, a[120:123] offset:12288
v_mfma_f32_16x16x32_bf16 v[60:63], a[168:171], a[156:159], 0
v_cvt_pk_bf16_f32 v24, v48, v49
v_cvt_pk_bf16_f32 v25, v50, v51
v_mfma_f32_16x16x32_bf16 a[96:99], v[112:115], v[36:39], a[72:75]
ds_write_b128 v11, a[124:127] offset:13312
v_mfma_f32_16x16x32_bf16 a[96:99], v[136:139], v[40:43], a[96:99]
v_cvt_pk_bf16_f32 v26, v52, v53
v_cvt_pk_bf16_f32 v27, v54, v55
v_mfma_f32_16x16x32_bf16 a[96:99], v[160:163], v[44:47], a[96:99]
s_waitcnt lgkmcnt(2)
v_cvt_pk_bf16_f32 v28, v56, v57
v_cvt_pk_bf16_f32 v29, v58, v59
v_mfma_f32_16x16x32_bf16 v[48:51], a[168:171], a[160:163], 0
ds_write_b128 v11, a[128:131] offset:14336
v_mfma_f32_16x16x32_bf16 v[52:55], a[168:171], a[164:167], 0
v_cvt_pk_bf16_f32 v30, v60, v61
v_cvt_pk_bf16_f32 v31, v62, v63
v_mfma_f32_16x16x32_bf16 a[100:103], v[164:167], v[44:47], a[76:79]
ds_write_b128 v11, a[132:135] offset:15360
v_mfma_f32_16x16x32_bf16 a[100:103], v[140:143], v[40:43], a[100:103]
v_cvt_pk_bf16_f32 v32, v48, v49
v_cvt_pk_bf16_f32 v33, v50, v51
v_mfma_f32_16x16x32_bf16 a[100:103], v[116:119], v[36:39], a[100:103]
ds_write_b128 v11, a[136:139] offset:16384
v_mfma_f32_16x16x32_bf16 a[104:107], v[120:123], v[36:39], a[80:83]
v_cvt_pk_bf16_f32 v34, v52, v53
v_cvt_pk_bf16_f32 v35, v54, v55
v_mfma_f32_16x16x32_bf16 a[104:107], v[144:147], v[40:43], a[104:107]
ds_write_b128 v11, a[140:143] offset:17408
v_mfma_f32_16x16x32_bf16 a[104:107], v[168:171], v[44:47], a[104:107]
v_mfma_f32_16x16x32_bf16 a[108:111], v[172:175], v[44:47], a[84:87]
v_mfma_f32_16x16x32_bf16 a[108:111], v[148:151], v[40:43], a[108:111]
v_mfma_f32_16x16x32_bf16 a[108:111], v[124:127], v[36:39], a[108:111]
s_waitcnt vmcnt(8) lgkmcnt(0)
s_barrier
v_mfma_f32_16x16x32_bf16 a[112:115], v[128:131], v[36:39], a[88:91]
LpgB0:
s_cbranch_vccnz Lpgdone
v_mfma_f32_16x16x32_bf16 a[112:115], v[152:155], v[40:43], a[112:115]
v_mfma_f32_16x16x32_bf16 a[112:115], v[176:179], v[44:47], a[112:115]
v_mfma_f32_16x16x32_bf16 a[116:119], v[180:183], v[44:47], a[92:95]
s_cmp_ge_u32 s39, s43
s_cselect_b32 s44, 2.0, s36
v_mfma_f32_16x16x32_bf16 a[116:119], v[156:159], v[40:43], a[116:119]
s_mov_b32 m0, s40
s_cmp_eq_u32 s38, s42
s_cselect_b32 s45, 2.0, 0
v_mfma_f32_16x16x32_bf16 a[116:119], v[132:135], v[36:39], a[116:119]
buffer_load_dwordx4 v5, s[12:15], s44 offen offset:0 nt lds
v_mfma_f32_16x16x32_bf16 a[72:75], a[0:3], v[36:39], 0
v_mfma_f32_16x16x32_bf16 a[72:75], v[20:23], v[40:43], a[72:75]
buffer_load_dwordx4 v6, s[12:15], s44 offen offset:1024 nt lds
v_mfma_f32_16x16x32_bf16 a[72:75], v[88:91], v[44:47], a[72:75]
v_mfma_f32_16x16x32_bf16 a[76:79], v[92:95], v[44:47], 0
v_mfma_f32_16x16x32_bf16 a[76:79], v[68:71], v[40:43], a[76:79]
v_mfma_f32_16x16x32_bf16 a[76:79], a[4:7], v[36:39], a[76:79]
buffer_load_dwordx4 v7, s[12:15], s44 offen offset:2048 nt lds
v_mfma_f32_16x16x32_bf16 a[80:83], a[8:11], v[36:39], 0
v_mfma_f32_16x16x32_bf16 a[80:83], v[72:75], v[40:43], a[80:83]
v_mfma_f32_16x16x32_bf16 a[80:83], v[96:99], v[44:47], a[80:83]
v_mfma_f32_16x16x32_bf16 a[84:87], v[100:103], v[44:47], 0
s_add_u32 m0, s40, s41
s_add_u32 s37, s37, 1
s_add_u32 s39, s39, 1
v_mfma_f32_16x16x32_bf16 a[84:87], v[76:79], v[40:43], a[84:87]
v_and_or_b32 v13, v12, s45, v8
v_mfma_f32_16x16x32_bf16 a[84:87], a[12:15], v[36:39], a[84:87]
buffer_load_dword v13, s[12:15], s44 offen nt lds
v_mfma_f32_16x16x32_bf16 a[88:91], a[16:19], v[36:39], 0
s_add_u32 s46, s46, 2
v_mfma_f32_16x16x32_bf16 a[88:91], v[80:83], v[40:43], a[88:91]
s_cmp_eq_u32 s37, 384
s_cselect_b32 s37, 0, s37
s_addc_u32 s38, s38, 0
v_mfma_f32_16x16x32_bf16 a[88:91], v[104:107], v[44:47], a[88:91]
s_cmp_eq_u32 s37, 0
s_cselect_b32 s49, -28231680, s48
s_add_u32 s36, s36, s49
v_mfma_f32_16x16x32_bf16 a[92:95], v[108:111], v[44:47], 0
s_add_u32 s40, s40, 6528
s_min_u32 s40, s40, s47
v_mfma_f32_16x16x32_bf16 a[92:95], v[84:87], v[40:43], a[92:95]
s_cmp_lt_u32 s46, 18
v_mfma_f32_16x16x32_bf16 a[92:95], v[16:19], v[36:39], a[92:95]
s_cbranch_scc1 LP_loop
s_branch LP_exit
LP_seam:
v_mfma_f32_16x16x32_bf16 a[120:123], a[244:247], a[244:247], a[96:99]
v_accvgpr_write_b32 a72, 0
v_accvgpr_write_b32 a73, 0
v_accvgpr_write_b32 a74, 0
v_accvgpr_write_b32 a75, 0
v_mfma_f32_16x16x32_bf16 a[124:127], a[244:247], a[244:247], a[100:103]
v_accvgpr_write_b32 a76, 0
v_accvgpr_write_b32 a77, 0
v_accvgpr_write_b32 a78, 0
v_accvgpr_write_b32 a79, 0
v_mfma_f32_16x16x32_bf16 a[128:131], a[244:247], a[244:247], a[104:107]
v_accvgpr_write_b32 a80, 0
v_accvgpr_write_b32 a81, 0
v_accvgpr_write_b32 a82, 0
v_accvgpr_write_b32 a83, 0
v_mfma_f32_16x16x32_bf16 a[132:135], a[244:247], a[244:247], a[108:111]
v_accvgpr_write_b32 a84, 0
v_accvgpr_write_b32 a85, 0
v_accvgpr_write_b32 a86, 0
v_accvgpr_write_b32 a87, 0
v_mfma_f32_16x16x32_bf16 a[136:139], a[244:247], a[244:247], a[112:115]
v_accvgpr_write_b32 a88, 0
v_accvgpr_write_b32 a89, 0
v_accvgpr_write_b32 a90, 0
v_accvgpr_write_b32 a91, 0
v_mfma_f32_16x16x32_bf16 a[140:143], a[244:247], a[244:247], a[116:119]
v_accvgpr_write_b32 a92, 0
v_accvgpr_write_b32 a93, 0
v_accvgpr_write_b32 a94, 0
v_accvgpr_write_b32 a95, 0
s_nop 0
s_branch LP_back
LP_exit:
v_mfma_f32_16x16x32_bf16 a[120:123], v[184:187], v[24:27], a[96:99]
s_mul_i32 s3, s29, 192
v_add_u32 v103, s3, v0
s_movk_i32 s4, 5462
v_mfma_f32_16x16x32_bf16 a[120:123], v[208:211], v[28:31], a[120:123]
v_add_u32 v105, 0, v103
v_mul_u32_u24 v107, s4, v105
v_mfma_f32_16x16x32_bf16 a[120:123], v[232:235], v[32:35], a[120:123]
v_lshrrev_b32 v107, 16, v107
v_mul_u32_u24 v96, 12, v107
v_mfma_f32_16x16x32_bf16 a[124:127], v[236:239], v[32:35], a[100:103]
v_sub_u32 v105, v105, v96
v_and_b32 v99, 1, v107
v_mfma_f32_16x16x32_bf16 a[124:127], v[212:215], v[28:31], a[124:127]
v_lshrrev_b32 v107, 1, v107
v_lshlrev_b32 v102, 31, v99
v_mfma_f32_16x16x32_bf16 a[124:127], v[188:191], v[24:27], a[124:127]
ds_write_b128 v15, a[120:123] offset:0
v_mfma_f32_16x16x32_bf16 a[128:131], v[192:195], v[24:27], a[104:107]
v_or_b32 v102, 1.0, v102
v_lshrrev_b32 v96, 1, v105
v_mfma_f32_16x16x32_bf16 a[128:131], v[216:219], v[28:31], a[128:131]
v_mul_u32_u24 v96, 69, v96
v_add_u32 v107, v107, v96
v_mfma_f32_16x16x32_bf16 a[128:131], v[240:243], v[32:35], a[128:131]
ds_write_b128 v15, a[124:127] offset:1104
v_mfma_f32_16x16x32_bf16 a[132:135], v[244:247], v[32:35], a[108:111]
v_and_b32 v105, 1, v105
v_mul_u32_u24 v105, 34, v105
v_mfma_f32_16x16x32_bf16 a[132:135], v[220:223], v[28:31], a[132:135]
ds_read_b128 a[144:147], v1 offset:6528
v_add_lshl_u32 v96, v105, v107, 4
v_mfma_f32_16x16x32_bf16 a[132:135], v[196:199], v[24:27], a[132:135]
ds_write_b128 v15, a[128:131] offset:2208
v_mfma_f32_16x16x32_bf16 a[136:139], v[200:203], v[24:27], a[112:115]
ds_read_b128 a[148:151], v2 offset:6528
v_mul_u32_u24 v99, 6656, v99
v_mfma_f32_16x16x32_bf16 a[136:139], v[224:227], v[28:31], a[136:139]
ds_read_b128 a[152:155], v3 offset:6528
v_add_u32 v99, v99, v96
v_mfma_f32_16x16x32_bf16 a[136:139], v[248:251], v[32:35], a[136:139]
ds_write_b128 v15, a[132:135] offset:3312
v_mfma_f32_16x16x32_bf16 a[140:143], v[252:255], v[32:35], a[116:119]
ds_read_b128 a[156:159], v4 offset:6528
v_add_u32 v105, 64, v103
v_mfma_f32_16x16x32_bf16 a[140:143], v[228:231], v[28:31], a[140:143]
v_mul_u32_u24 v107, s4, v105
v_lshrrev_b32 v107, 16, v107
v_mfma_f32_16x16x32_bf16 a[140:143], v[204:207], v[24:27], a[140:143]
ds_write_b128 v15, a[136:139] offset:4416
v_mfma_f32_16x16x32_bf16 a[96:99], v[112:115], v[24:27], a[72:75]
ds_read_b128 a[160:163], v1 offset:6656
v_mul_u32_u24 v97, 12, v107
v_mfma_f32_16x16x32_bf16 a[96:99], v[136:139], v[28:31], a[96:99]
ds_read_b128 a[164:167], v2 offset:6656
v_sub_u32 v105, v105, v97
v_mfma_f32_16x16x32_bf16 a[96:99], v[160:163], v[32:35], a[96:99]
s_waitcnt lgkmcnt(6)
v_and_b32 v100, 1, v107
v_lshrrev_b32 v107, 1, v107
v_mfma_f32_16x16x32_bf16 v[48:51], a[168:171], a[144:147], 0
ds_write_b128 v15, a[140:143] offset:5520
v_mfma_f32_16x16x32_bf16 v[52:55], a[168:171], a[148:151], 0
s_waitcnt lgkmcnt(4)
v_lshlrev_b32 v104, 31, v100
v_or_b32 v104, 1.0, v104
v_mfma_f32_16x16x32_bf16 v[56:59], a[168:171], a[152:155], 0
v_lshrrev_b32 v97, 1, v105
v_mul_u32_u24 v97, 69, v97
v_mfma_f32_16x16x32_bf16 v[60:63], a[168:171], a[156:159], 0
v_add_u32 v107, v107, v97
v_and_b32 v105, 1, v105
v_mfma_f32_16x16x32_bf16 a[100:103], v[164:167], v[32:35], a[76:79]
v_mul_u32_u24 v105, 34, v105
v_add_lshl_u32 v97, v105, v107, 4
v_mfma_f32_16x16x32_bf16 a[100:103], v[140:143], v[28:31], a[100:103]
v_mul_u32_u24 v100, 6656, v100
v_add_u32 v100, v100, v97
v_mfma_f32_16x16x32_bf16 a[100:103], v[116:119], v[24:27], a[100:103]
v_add_u32 v105, 128, v103
v_mul_u32_u24 v107, s4, v105
v_lshrrev_b32 v107, 16, v107
v_mul_u32_u24 v98, 12, v107
v_sub_u32 v105, v105, v98
v_and_b32 v101, 1, v107
v_lshrrev_b32 v107, 1, v107
v_lshlrev_b32 v106, 31, v101
v_or_b32 v106, 1.0, v106
v_lshrrev_b32 v98, 1, v105
v_mul_u32_u24 v98, 69, v98
v_add_u32 v107, v107, v98
v_and_b32 v105, 1, v105
v_mul_u32_u24 v105, 34, v105
v_add_lshl_u32 v98, v105, v107, 4
v_mul_u32_u24 v101, 6656, v101
v_cvt_pk_bf16_f32 v36, v48, v49
v_add_u32 v101, v101, v98
v_cvt_pk_bf16_f32 v37, v50, v51
s_waitcnt lgkmcnt(1)
v_mfma_f32_16x16x32_bf16 v[48:51], a[168:171], a[160:163], 0
v_lshlrev_b32 v103, 4, v103
v_cvt_pk_bf16_f32 v38, v52, v53
v_cvt_pk_bf16_f32 v39, v54, v55
v_mfma_f32_16x16x32_bf16 v[52:55], a[168:171], a[164:167], 0
v_cvt_pk_bf16_f32 v40, v56, v57
v_cvt_pk_bf16_f32 v41, v58, v59
v_mfma_f32_16x16x32_bf16 a[104:107], v[120:123], v[24:27], a[80:83]
v_cvt_pk_bf16_f32 v42, v60, v61
v_cvt_pk_bf16_f32 v43, v62, v63
v_mfma_f32_16x16x32_bf16 a[104:107], v[144:147], v[28:31], a[104:107]
v_cvt_pk_bf16_f32 v44, v48, v49
v_cvt_pk_bf16_f32 v45, v50, v51
v_mfma_f32_16x16x32_bf16 a[104:107], v[168:171], v[32:35], a[104:107]
s_waitcnt lgkmcnt(0)
s_barrier
v_cvt_pk_bf16_f32 v46, v52, v53
v_mfma_f32_16x16x32_bf16 a[108:111], v[172:175], v[32:35], a[84:87]
ds_read_b128 v[72:75], v99 offset:26368
v_cvt_pk_bf16_f32 v47, v54, v55
v_mfma_f32_16x16x32_bf16 a[108:111], v[148:151], v[28:31], a[108:111]
ds_read_b128 v[76:79], v99 offset:26640
v_mfma_f32_16x16x32_bf16 a[108:111], v[124:127], v[24:27], a[108:111]
ds_read_b128 v[80:83], v96 offset:13056
v_mfma_f32_16x16x32_bf16 a[112:115], v[128:131], v[24:27], a[88:91]
ds_read_b128 v[84:87], v96 offset:13328
v_mfma_f32_16x16x32_bf16 a[112:115], v[152:155], v[28:31], a[112:115]
ds_read_b128 v[88:91], v96 offset:19712
v_mfma_f32_16x16x32_bf16 a[112:115], v[176:179], v[32:35], a[112:115]
ds_read_b128 v[92:95], v96 offset:19984
s_waitcnt lgkmcnt(2)
v_mfma_f32_16x16x32_bf16 a[116:119], v[180:183], v[32:35], a[92:95]
ds_read_b128 v[48:51], v100 offset:26368
v_add_f32 v72, v72, v80
v_mfma_f32_16x16x32_bf16 a[116:119], v[156:159], v[28:31], a[116:119]
ds_read_b128 v[52:55], v100 offset:26640
v_add_f32 v73, v73, v81
v_mfma_f32_16x16x32_bf16 a[116:119], v[132:135], v[24:27], a[116:119]
ds_read_b128 v[56:59], v97 offset:13056
v_add_f32 v74, v74, v82
v_mfma_f32_16x16x32_bf16 a[120:123], v[184:187], v[36:39], a[96:99]
ds_read_b128 v[60:63], v97 offset:13328
v_add_f32 v75, v75, v83
v_mfma_f32_16x16x32_bf16 a[120:123], v[208:211], v[40:43], a[120:123]
ds_read_b128 v[64:67], v97 offset:19712
v_add_f32 v76, v76, v84
v_mfma_f32_16x16x32_bf16 a[120:123], v[232:235], v[44:47], a[120:123]
ds_read_b128 v[108:111], v97 offset:19984
v_add_f32 v77, v77, v85
v_mfma_f32_16x16x32_bf16 a[124:127], v[236:239], v[44:47], a[100:103]
s_waitcnt lgkmcnt(6)
v_add_f32 v78, v78, v86
v_add_f32 v79, v79, v87
v_mfma_f32_16x16x32_bf16 a[124:127], v[212:215], v[40:43], a[124:127]
v_fma_f32 v72, v88, v102, v72
v_fma_f32 v73, v89, v102, v73
v_mfma_f32_16x16x32_bf16 a[124:127], v[188:191], v[36:39], a[124:127]
ds_write_b128 v15, a[120:123] offset:26624
v_mfma_f32_16x16x32_bf16 a[128:131], v[192:195], v[36:39], a[104:107]
v_fma_f32 v74, v90, v102, v74
v_fma_f32 v75, v91, v102, v75
v_mfma_f32_16x16x32_bf16 a[128:131], v[216:219], v[40:43], a[128:131]
v_fma_f32 v76, v92, v102, v76
v_fma_f32 v77, v93, v102, v77
v_mfma_f32_16x16x32_bf16 a[128:131], v[240:243], v[44:47], a[128:131]
ds_write_b128 v15, a[124:127] offset:27728
v_mfma_f32_16x16x32_bf16 a[132:135], v[244:247], v[44:47], a[108:111]
v_fma_f32 v78, v94, v102, v78
v_fma_f32 v79, v95, v102, v79
v_mfma_f32_16x16x32_bf16 a[132:135], v[220:223], v[40:43], a[132:135]
v_cvt_pk_bf16_f32 v80, v72, v73
v_cvt_pk_bf16_f32 v81, v74, v75
v_mfma_f32_16x16x32_bf16 a[132:135], v[196:199], v[36:39], a[132:135]
ds_write_b128 v15, a[128:131] offset:28832
v_mfma_f32_16x16x32_bf16 a[136:139], v[200:203], v[36:39], a[112:115]
v_cvt_pk_bf16_f32 v82, v76, v77
v_cvt_pk_bf16_f32 v83, v78, v79
v_mfma_f32_16x16x32_bf16 a[136:139], v[224:227], v[40:43], a[136:139]
buffer_store_dwordx4 v[80:83], v103, s[20:23], s56 offen offset:0 sc1
v_mfma_f32_16x16x32_bf16 a[136:139], v[248:251], v[44:47], a[136:139]
ds_write_b128 v15, a[132:135] offset:29936
v_mfma_f32_16x16x32_bf16 a[140:143], v[252:255], v[44:47], a[116:119]
ds_read_b128 v[72:75], v101 offset:26368
s_waitcnt lgkmcnt(7)
v_mfma_f32_16x16x32_bf16 a[140:143], v[228:231], v[40:43], a[140:143]
ds_read_b128 v[76:79], v101 offset:26640
v_add_f32 v48, v48, v56
v_mfma_f32_16x16x32_bf16 a[140:143], v[204:207], v[36:39], a[140:143]
ds_write_b128 v15, a[136:139] offset:31040
ds_read_b128 v[80:83], v98 offset:13056
ds_read_b128 v[84:87], v98 offset:13328
ds_read_b128 v[88:91], v98 offset:19712
ds_read_b128 v[92:95], v98 offset:19984
v_add_f32 v49, v49, v57
v_add_f32 v50, v50, v58
v_add_f32 v51, v51, v59
v_add_f32 v52, v52, v60
ds_write_b128 v15, a[140:143] offset:32144
s_waitcnt lgkmcnt(0)
s_barrier
v_add_f32 v53, v53, v61
v_pk_add_f32 v[54:55], v[54:55], v[62:63]
v_pk_fma_f32 v[48:49], v[64:65], v[104:105], v[48:49] op_sel_hi:[1,0,1]
v_pk_fma_f32 v[50:51], v[66:67], v[104:105], v[50:51] op_sel_hi:[1,0,1]
v_pk_fma_f32 v[52:53], v[108:109], v[104:105], v[52:53] op_sel_hi:[1,0,1]
v_pk_fma_f32 v[54:55], v[110:111], v[104:105], v[54:55] op_sel_hi:[1,0,1]
v_cvt_pk_bf16_f32 v56, v48, v49
v_cvt_pk_bf16_f32 v57, v50, v51
v_cvt_pk_bf16_f32 v58, v52, v53
v_cvt_pk_bf16_f32 v59, v54, v55
buffer_store_dwordx4 v[56:59], v103, s[20:23], s56 offen offset:1024 sc1
v_pk_add_f32 v[72:73], v[72:73], v[80:81]
v_pk_add_f32 v[74:75], v[74:75], v[82:83]
v_pk_add_f32 v[76:77], v[76:77], v[84:85]
v_pk_add_f32 v[78:79], v[78:79], v[86:87]
v_pk_fma_f32 v[72:73], v[88:89], v[106:107], v[72:73] op_sel_hi:[1,0,1]
v_pk_fma_f32 v[74:75], v[90:91], v[106:107], v[74:75] op_sel_hi:[1,0,1]
v_pk_fma_f32 v[76:77], v[92:93], v[106:107], v[76:77] op_sel_hi:[1,0,1]
v_pk_fma_f32 v[78:79], v[94:95], v[106:107], v[78:79] op_sel_hi:[1,0,1]
v_cvt_pk_bf16_f32 v80, v72, v73
v_cvt_pk_bf16_f32 v81, v74, v75
v_cvt_pk_bf16_f32 v82, v76, v77
v_cvt_pk_bf16_f32 v83, v78, v79
buffer_store_dwordx4 v[80:83], v103, s[20:23], s56 offen offset:2048 sc1
s_endpgm
Lend:
s_endpgm
.section .rodata,"a"
.p2align 6
.amdhsa_kernel standalone__winograd__vision_kernel
  .amdhsa_next_free_vgpr 512
  .amdhsa_next_free_sgpr 102
  .amdhsa_accum_offset 256
  .amdhsa_group_segment_fixed_size 0
  .amdhsa_kernarg_size 40
  .amdhsa_user_sgpr_count 2
  .amdhsa_user_sgpr_kernarg_segment_ptr 1
  .amdhsa_system_sgpr_workgroup_id_x 1
.end_amdhsa_kernel
```
